```python
import torch

def _softmax(x, axis=-1):
    return torch.softmax(x, dim=axis)
def _gelu(x):
    return torch.nn.functional.gelu(x, approximate="tanh")
def _silu(x):
    return torch.nn.functional.silu(x)
def _sigmoid(x):
    return torch.sigmoid(x)
def _layernorm(x, axis=-1, eps=1e-5):
    m = x.mean(dim=axis, keepdim=True)
    v = x.var(dim=axis, keepdim=True, unbiased=False)
    return (x - m) / torch.sqrt(v + eps)
def _scatter_add(tgt, idx, src, axis=0):
    return tgt.clone().index_add_(axis, idx, src)
def _segment_sum(src, seg, n):
    out = torch.zeros((n,) + src.shape[1:], dtype=src.dtype)
    return out.index_add_(0, seg, src)
def _pad(x, pw):
    flat = tuple(v for pair in reversed(pw) for v in pair)
    return torch.nn.functional.pad(x, flat)

kernel_name = 'parallel_sum__mha_block_cached__glu_gated_glu__decode'

def setup_inputs():

    _w = (lambda a: (lambda t: t.to(torch.bfloat16) if t.is_floating_point() else t)(torch.as_tensor(a)))
    def _A_setup():
        B, Sq, D = 1, 1, 1024
        H, Sk, Dh = 32, 65536, 128
        return {
            "x": _w((lambda *s: torch.randn(*s, dtype=torch.bfloat16) * 0.05)(B, Sq, D)),
            "k_cache": _w((lambda *s: torch.randn(*s, dtype=torch.bfloat16) * 3.2)(B, H, Sk, Dh)),
            "v_cache": _w((lambda *s: torch.randn(*s, dtype=torch.bfloat16) * 1.6)(B, H, Sk, Dh)),
            "wq": _w((lambda *s: torch.randn(*s, dtype=torch.bfloat16) * 3.2)(D, H * Dh) * (D ** -0.5)),
            "wo": _w((lambda *s: torch.randn(*s, dtype=torch.bfloat16) * 1.6)(H * Dh, D) * ((H * Dh) ** -0.5)),
        }
    _A_in = _A_setup()

    def _B_setup():
        B, S, D, F = 1, 1, 1024, 3584
        return {
            "x": _w((lambda *s: torch.randn(*s, dtype=torch.bfloat16) * 0.05)(B, S, D)),
            "w_gate": _w((lambda *s: torch.randn(*s, dtype=torch.bfloat16) * 0.05)(D, F)),
            "w_up": _w((lambda *s: torch.randn(*s, dtype=torch.bfloat16) * 0.05)(D, F)),
            "w_down": _w((lambda *s: torch.randn(*s, dtype=torch.bfloat16) * 0.05)(F, D)),
        }
    _B_in = _B_setup()

    return {
        "A_x": _A_in["x"],
        "A_k_cache": _A_in["k_cache"],
        "A_v_cache": _A_in["v_cache"],
        "A_wq": _A_in["wq"],
        "A_wo": _A_in["wo"],
        "B_x": _B_in["x"],
        "B_w_gate": _B_in["w_gate"],
        "B_w_up": _B_in["w_up"],
        "B_w_down": _B_in["w_down"],
    }

def reference(A_x, A_k_cache, A_v_cache, A_wq, A_wo, B_x, B_w_gate, B_w_up, B_w_down):
    def _A_ref(x, k_cache, v_cache, wq, wo):
        B, Sq, D = x.shape
        H, Dh = 32, 128
        q = (lambda x, *d: x.permute(*d))((x @ wq).reshape(B, Sq, H, Dh), 0, 2, 1, 3)
        scores = torch.einsum("bhqd,bhkd->bhqk", q, k_cache) * (Dh ** -0.5)
        p = _softmax(scores, axis=-1)
        o = torch.einsum("bhqk,bhkd->bhqd", p, v_cache)
        return (lambda x, *d: x.permute(*d))(o, 0, 2, 1, 3).reshape(B, Sq, H * Dh) @ wo

    def _B_ref(x, w_gate, w_up, w_down):
        g = torch.einsum("bsd,df->bsf", x, w_gate)
        u = torch.einsum("bsd,df->bsf", x, w_up)
        h = _sigmoid(g) * u
        return torch.einsum("bsf,fd->bsd", h, w_down)

    x = A_x
    xn = _layernorm(x, axis=-1)
    return x + _A_ref(xn, A_k_cache, A_v_cache, A_wq, A_wo) + _B_ref(xn, B_w_gate, B_w_up, B_w_down)
```

```asm
; @launch grid=(256,1,1) block=(320,1,1) lds=24576
.amdgcn_target "amdgcn-amd-amdhsa--gfx950"
.text
.globl parallel_sum__mha_block_cached__glu_gated_glu__decode_kernel
.p2align 8
.type parallel_sum__mha_block_cached__glu_gated_glu__decode_kernel,@function
parallel_sum__mha_block_cached__glu_gated_glu__decode_kernel:
  s_cmp_ge_u32 s2, 256
  s_cbranch_scc1 L_end
  s_load_dwordx16 s[16:31], s[0:1], 0
  s_load_dwordx8 s[32:39], s[0:1], 64
  s_getpc_b64 s[40:41]
L_pc0:
  v_lshlrev_b32 v2, 6, v0
  v_min_u32 v2, L_codeend-L_pc0-4, v2
  global_load_dword v11, v2, s[40:41]
  v_lshrrev_b32 v1, 6, v0
  v_and_b32 v0, 63, v0
  s_lshr_b32 s4, s2, 3
  s_and_b32 s5, s2, 7
  v_readfirstlane_b32 s3, v1
  v_lshlrev_b32 v1, 4, v0
  s_mov_b32 s6, 0x3fb8aa3b
  s_mov_b32 s7, 0xffff0000
  s_cmp_eq_u32 s3, 0
  s_cbranch_scc1 L_service
  s_sub_u32 s3, s3, 1
  s_lshl_b32 s10, s4, 24
  s_mov_b32 s42, 0x1000000
  s_mov_b32 s43, 0x20000
  s_lshl_b32 s69, s5, 21
  s_and_b32 s65, s3, 1
  s_lshl_b32 s65, s65, 12
  s_add_u32 s62, s69, s65
  s_bfe_u32 s65, s3, 0x10001
  s_lshl_b32 s65, s65, 15
  s_add_u32 s62, s62, s65
  s_mov_b32 s70, 0
  s_mov_b32 s73, 0
  s_bfe_u32 s65, s2, 65537
  s_lshl_b32 s65, s65, 3
  s_xor_b32 s73, s73, s65
  s_bfe_u32 s65, s2, 65537
  s_lshl_b32 s65, s65, 1
  s_xor_b32 s73, s73, s65
  s_bfe_u32 s65, s2, 65538
  s_lshl_b32 s65, s65, 4
  s_xor_b32 s73, s73, s65
  s_xor_b32 s64, s70, s73
  s_bfe_u32 s65, s64, 65536
  s_lshl_b32 s65, s65, 16
  s_add_u32 s52, s62, s65
  s_bfe_u32 s65, s64, 65537
  s_lshl_b32 s65, s65, 10
  s_add_u32 s52, s52, s65
  s_bfe_u32 s65, s64, 262146
  s_lshl_b32 s65, s65, 17
  s_add_u32 s52, s52, s65
  s_add_u32 s53, s52, 8192
  s_add_u32 s66, s52, 16384
  s_add_u32 s67, s52, 24576
  s_waitcnt lgkmcnt(0)
  s_add_u32 s40, s18, s10
  s_addc_u32 s41, s19, 0
  buffer_load_dwordx4 v[88:91], v1, s[40:43], s52 offen offset:0 nt
  buffer_load_dwordx4 v[92:95], v1, s[40:43], s53 offen offset:0 nt
  buffer_load_dwordx4 v[96:99], v1, s[40:43], s66 offen offset:0 nt
  buffer_load_dwordx4 v[100:103], v1, s[40:43], s67 offen offset:0 nt
  buffer_load_dwordx4 v[104:107], v1, s[40:43], s52 offen offset:2048 nt
  buffer_load_dwordx4 v[108:111], v1, s[40:43], s53 offen offset:2048 nt
  s_barrier
  s_setprio 2
  s_add_u32 s50, s20, s10
  s_addc_u32 s51, s21, 0
  v_and_b32 v2, 15, v0
  v_and_b32 v3, 1, v0
  v_mov_b32 v7, 0xffff
  v_lshlrev_b32 v3, 4, v3
  v_lshlrev_b32 v3, v3, v7
  v_lshrrev_b32 v7, 1, v2
  v_cmp_eq_u32 vcc, 0, v7
  s_nop 1
  v_cndmask_b32 v4, 0, v3, vcc
  v_cmp_eq_u32 vcc, 1, v7
  s_nop 1
  v_cndmask_b32 v5, 0, v3, vcc
  v_cmp_eq_u32 vcc, 2, v7
  s_nop 1
  v_cndmask_b32 v6, 0, v3, vcc
  v_cmp_eq_u32 vcc, 3, v7
  s_nop 1
  v_cndmask_b32 v7, 0, v3, vcc
  v_lshlrev_b32 v2, 5, v2
  v_and_b32 v3, 48, v0
  v_add_u32 v2, v2, v3
  s_mov_b32 s8, 0x3db504f3
  s_mov_b32 s63, 3
  s_mov_b32 s12, s38
  s_mov_b32 s13, s39
  s_mov_b32 s14, 786432
  s_mov_b32 s15, 0x20000
  v_mov_b32 v12, 0
  v_mov_b32 v13, 0
  v_mov_b32 v14, 0
  v_mov_b32 v15, 0
  v_mov_b32 v17, 0
  v_and_b32 v3, 0xf0, v1
  s_lshl_b32 s72, s3, 6
  s_add_u32 s72, s72, 8192
  v_and_b32 v54, 48, v0
  v_add_u32 v53, s72, v54
  s_mov_b32 s76, 0x00010001
  s_mov_b32 s77, 0x00010001
  s_mov_b32 s26, 0x800000
  s_mov_b32 s27, 0x20000
  s_mov_b32 s34, 7340032
  s_mov_b32 s35, 0x20000
  s_lshl_b32 s9, s3, 2
  v_mov_b32 v33, s9
  v_mov_b32 v52, 0
  s_mov_b32 s61, 0
  v_mov_b32 v55, v53
  s_call_b64 s[78:79], L_bodyX
  v_mov_b32 v55, v53
  v_add_u32 v53, 512, v53
  s_waitcnt vmcnt(4)
  buffer_load_dwordx4 v[112:115], v1, s[40:43], s66 offen offset:2048 nt
  buffer_load_dwordx4 v[116:119], v1, s[40:43], s67 offen offset:2048 nt
  s_add_u32 s70, s70, 1
  s_xor_b32 s64, s70, s73
  s_bfe_u32 s65, s64, 65536
  s_lshl_b32 s65, s65, 16
  s_add_u32 s52, s62, s65
  s_bfe_u32 s65, s64, 65537
  s_lshl_b32 s65, s65, 10
  s_add_u32 s52, s52, s65
  s_bfe_u32 s65, s64, 262146
  s_lshl_b32 s65, s65, 17
  s_add_u32 s52, s52, s65
  s_add_u32 s53, s52, 8192
  s_add_u32 s66, s52, 16384
  s_add_u32 s67, s52, 24576
  s_waitcnt vmcnt(4)
  buffer_load_dwordx4 v[120:123], v1, s[40:43], s52 offen offset:0 nt
  buffer_load_dwordx4 v[124:127], v1, s[40:43], s53 offen offset:0 nt
  s_waitcnt vmcnt(4)
  buffer_load_dwordx4 v[128:131], v1, s[40:43], s66 offen offset:0 nt
  buffer_load_dwordx4 v[132:135], v1, s[40:43], s67 offen offset:0 nt
  s_waitcnt vmcnt(4)
  buffer_load_dwordx4 v[136:139], v1, s[40:43], s52 offen offset:2048 nt
  buffer_load_dwordx4 v[140:143], v1, s[40:43], s53 offen offset:2048 nt
  s_waitcnt vmcnt(4)
  buffer_load_dwordx4 v[144:147], v1, s[40:43], s66 offen offset:2048 nt
  buffer_load_dwordx4 v[148:151], v1, s[40:43], s67 offen offset:2048 nt
  s_add_u32 s70, s70, 1
  s_xor_b32 s64, s70, s73
  s_bfe_u32 s65, s64, 65536
  s_lshl_b32 s65, s65, 16
  s_add_u32 s52, s62, s65
  s_bfe_u32 s65, s64, 65537
  s_lshl_b32 s65, s65, 10
  s_add_u32 s52, s52, s65
  s_bfe_u32 s65, s64, 262146
  s_lshl_b32 s65, s65, 17
  s_add_u32 s52, s52, s65
  s_add_u32 s53, s52, 8192
  s_add_u32 s66, s52, 16384
  s_add_u32 s67, s52, 24576
  s_waitcnt vmcnt(4)
  buffer_load_dwordx4 v[152:155], v1, s[40:43], s52 offen offset:0 nt
  buffer_load_dwordx4 v[156:159], v1, s[40:43], s53 offen offset:0 nt
  s_waitcnt vmcnt(4)
  buffer_load_dwordx4 v[160:163], v1, s[40:43], s66 offen offset:0 nt
  buffer_load_dwordx4 v[164:167], v1, s[40:43], s67 offen offset:0 nt
  s_waitcnt vmcnt(4)
  buffer_load_dwordx4 v[168:171], v1, s[40:43], s52 offen offset:2048 nt
  buffer_load_dwordx4 v[172:175], v1, s[40:43], s53 offen offset:2048 nt
  s_waitcnt vmcnt(4)
  buffer_load_dwordx4 v[176:179], v1, s[40:43], s66 offen offset:2048 nt
  buffer_load_dwordx4 v[180:183], v1, s[40:43], s67 offen offset:2048 nt
  s_call_b64 s[78:79], L_bodyA
  s_branch L_str2
L_service:
  v_mov_b32 v4, 0
  v_mov_b32 v5, 0
  v_mov_b32 v6, 0
  v_mov_b32 v7, 0
  s_mov_b64 exec, 7
  ds_write_b128 v1, v[4:7] offset:288
  s_mov_b64 exec, -1
  v_lshrrev_b32 v26, 4, v0
  v_and_b32 v27, 0xf0, v1
  v_lshlrev_b32 v24, 18, v26
  v_add_u32 v24, v24, v27
  v_lshlrev_b32 v25, 2, v0
  s_lshl_b32 s8, s5, 8
  s_lshl_b32 s44, s5, 20
  s_lshl_b32 s9, s4, 8
  s_add_u32 s44, s44, s9
  s_movk_i32 s45, 8192
  s_movk_i32 s50, 2048
  s_mov_b32 s51, 0x20000
  s_mov_b32 s42, 0x800000
  s_mov_b32 s43, 0x20000
  s_waitcnt lgkmcnt(0)
  s_barrier
  s_mov_b32 s48, s16
  s_mov_b32 s49, s17
  s_mov_b32 s40, s22
  s_mov_b32 s41, s23
  buffer_load_dwordx4 v[32:35], v1, s[48:51], 0 offen
  buffer_load_dwordx4 v[36:39], v1, s[48:51], 0 offen offset:1024
  buffer_load_dword v8, v25, s[48:51], s8 offen
  s_xor_b32 s9, s8, 256
  buffer_load_dword v58, v25, s[48:51], s9 offen
  s_call_b64 s[46:47], L_loadtile
  s_mov_b32 s12, s38
  s_mov_b32 s13, s39
  s_mov_b32 s14, 786432
  s_mov_b32 s15, 0x20000
  buffer_load_dword v56, off, s[12:15], 0 offset:0 sc1
  s_lshl_b32 s64, s2, 9
  s_add_u32 s60, s64, 262144
  s_add_u32 s64, s64, 131072
  s_lshl_b32 s66, s4, 12
  s_add_u32 s67, s66, 262144
  s_add_u32 s66, s66, 131072
  v_lshlrev_b32 v10, 3, v0
  v_and_b32 v2, 15, v0
  v_and_b32 v3, 1, v0
  v_mov_b32 v7, 0xffff
  v_lshlrev_b32 v3, 4, v3
  v_lshlrev_b32 v3, v3, v7
  v_lshrrev_b32 v7, 1, v2
  v_cmp_eq_u32 vcc, 0, v7
  s_nop 1
  v_cndmask_b32 v4, 0, v3, vcc
  v_cmp_eq_u32 vcc, 1, v7
  s_nop 1
  v_cndmask_b32 v5, 0, v3, vcc
  v_cmp_eq_u32 vcc, 2, v7
  s_nop 1
  v_cndmask_b32 v6, 0, v3, vcc
  v_cmp_eq_u32 vcc, 3, v7
  s_nop 1
  v_cndmask_b32 v7, 0, v3, vcc
  v_lshlrev_b32 v2, 5, v2
  v_and_b32 v3, 48, v0
  v_add_u32 v2, v2, v3
  s_waitcnt vmcnt(33)
  v_lshlrev_b32 v40, 16, v32
  v_and_b32 v41, s7, v32
  v_lshlrev_b32 v42, 16, v33
  v_and_b32 v43, s7, v33
  v_lshlrev_b32 v44, 16, v34
  v_and_b32 v45, s7, v34
  v_lshlrev_b32 v46, 16, v35
  v_and_b32 v47, s7, v35
  v_lshlrev_b32 v48, 16, v36
  v_and_b32 v49, s7, v36
  v_lshlrev_b32 v50, 16, v37
  v_and_b32 v51, s7, v37
  v_lshlrev_b32 v52, 16, v38
  v_and_b32 v53, s7, v38
  v_lshlrev_b32 v54, 16, v39
  v_and_b32 v55, s7, v39
  v_add_f32 v32, v40, v41
  v_add_f32 v33, v42, v43
  v_add_f32 v34, v44, v45
  v_add_f32 v35, v46, v47
  v_add_f32 v36, v48, v49
  v_add_f32 v37, v50, v51
  v_add_f32 v38, v52, v53
  v_add_f32 v39, v54, v55
  v_add_f32 v32, v32, v36
  v_add_f32 v33, v33, v37
  v_add_f32 v34, v34, v38
  v_add_f32 v35, v35, v39
  v_add_f32 v32, v32, v33
  v_add_f32 v34, v34, v35
  v_add_f32 v32, v32, v34
  s_nop 1
  v_add_f32_dpp v32, v32, v32 row_ror:8 row_mask:0xf bank_mask:0xf
  s_nop 1
  v_add_f32_dpp v32, v32, v32 row_ror:4 row_mask:0xf bank_mask:0xf
  s_nop 1
  v_add_f32_dpp v32, v32, v32 row_ror:2 row_mask:0xf bank_mask:0xf
  s_nop 1
  v_add_f32_dpp v32, v32, v32 row_ror:1 row_mask:0xf bank_mask:0xf
  v_mov_b32 v33, v32
  s_nop 1
  v_permlane32_swap_b32 v32, v33
  s_nop 0
  v_add_f32 v32, v32, v33
  v_mov_b32 v33, v32
  s_nop 1
  v_permlane16_swap_b32 v32, v33
  s_nop 0
  v_add_f32 v32, v32, v33
  v_mul_f32 v32, 0x3a800000, v32
  v_sub_f32 v40, v40, v32
  v_sub_f32 v41, v41, v32
  v_sub_f32 v42, v42, v32
  v_sub_f32 v43, v43, v32
  v_sub_f32 v44, v44, v32
  v_sub_f32 v45, v45, v32
  v_sub_f32 v46, v46, v32
  v_sub_f32 v47, v47, v32
  v_sub_f32 v48, v48, v32
  v_sub_f32 v49, v49, v32
  v_sub_f32 v50, v50, v32
  v_sub_f32 v51, v51, v32
  v_sub_f32 v52, v52, v32
  v_sub_f32 v53, v53, v32
  v_sub_f32 v54, v54, v32
  v_sub_f32 v55, v55, v32
  v_mul_f32 v34, v40, v40
  v_mul_f32 v35, v41, v41
  v_fmac_f32 v34, v42, v42
  v_fmac_f32 v35, v43, v43
  v_fmac_f32 v34, v44, v44
  v_fmac_f32 v35, v45, v45
  v_fmac_f32 v34, v46, v46
  v_fmac_f32 v35, v47, v47
  v_fmac_f32 v34, v48, v48
  v_fmac_f32 v35, v49, v49
  v_fmac_f32 v34, v50, v50
  v_fmac_f32 v35, v51, v51
  v_fmac_f32 v34, v52, v52
  v_fmac_f32 v35, v53, v53
  v_fmac_f32 v34, v54, v54
  v_fmac_f32 v35, v55, v55
  v_add_f32 v34, v34, v35
  s_nop 1
  v_add_f32_dpp v34, v34, v34 row_ror:8 row_mask:0xf bank_mask:0xf
  s_nop 1
  v_add_f32_dpp v34, v34, v34 row_ror:4 row_mask:0xf bank_mask:0xf
  s_nop 1
  v_add_f32_dpp v34, v34, v34 row_ror:2 row_mask:0xf bank_mask:0xf
  s_nop 1
  v_add_f32_dpp v34, v34, v34 row_ror:1 row_mask:0xf bank_mask:0xf
  v_mov_b32 v33, v34
  s_nop 1
  v_permlane32_swap_b32 v34, v33
  s_nop 0
  v_add_f32 v34, v34, v33
  v_mov_b32 v33, v34
  s_nop 1
  v_permlane16_swap_b32 v34, v33
  s_nop 0
  v_add_f32 v34, v34, v33
  v_mul_f32 v34, 0x3a800000, v34
  v_cvt_pk_bf16_f32 v33, v32, v34
  v_lshlrev_b32 v32, 16, v33
  v_and_b32 v34, s7, v33
  v_add_f32 v34, 0x3727c5ac, v34
  v_cvt_pk_bf16_f32 v34, v34, v34
  v_and_b32 v34, s7, v34
  v_sqrt_f32 v34, v34
  s_nop 0
  v_cvt_pk_bf16_f32 v34, v34, v34
  v_and_b32 v34, s7, v34
  v_rcp_f32 v34, v34
  v_and_b32 v9, s7, v8
  v_lshlrev_b32 v8, 16, v8
  v_sub_f32 v8, v8, v32
  v_sub_f32 v9, v9, v32
  v_cvt_pk_bf16_f32 v9, v8, v9
  v_lshlrev_b32 v8, 16, v9
  v_and_b32 v9, s7, v9
  v_mul_f32 v8, v8, v34
  v_mul_f32 v9, v9, v34
  v_cvt_pk_bf16_f32 v8, v8, v8
  v_cvt_pk_bf16_f32 v9, v9, v9
  v_and_b32 v59, s7, v58
  v_lshlrev_b32 v58, 16, v58
  v_sub_f32 v58, v58, v32
  v_sub_f32 v59, v59, v32
  v_cvt_pk_bf16_f32 v59, v58, v59
  v_lshlrev_b32 v58, 16, v59
  v_and_b32 v59, s7, v59
  v_mul_f32 v58, v58, v34
  v_mul_f32 v59, v59, v34
  v_cvt_pk_bf16_f32 v58, v58, v58
  v_cvt_pk_bf16_f32 v59, v59, v59
  v_bfe_u32 v25, v0, 4, 1
  v_lshl_add_u32 v25, v25, 3, v27
  v_lshrrev_b32 v3, 5, v0
  v_lshl_add_u32 v25, v3, 2, v25
  s_waitcnt vmcnt(0)
  v_add_u32 v56, 0x9e3779b9, v56
  v_and_b32 v28, 1, v0
  v_lshlrev_b32 v28, 4, v28
  v_lshrrev_b32 v28, v28, v56
  v_bfe_u32 v64, v28, 0, 4
  v_bfe_u32 v65, v28, 4, 4
  v_bfe_u32 v66, v28, 8, 4
  v_bfe_u32 v67, v28, 12, 4
  s_call_b64 s[46:47], L_matvec
  v_add_u32 v12, 8, v12
  v_add_u32 v13, 8, v13
  v_add_u32 v14, 8, v14
  v_add_u32 v15, 8, v15
  v_bfi_b32 v12, 15, v64, v12
  v_bfi_b32 v13, 15, v65, v13
  v_bfi_b32 v14, 15, v66, v14
  v_bfi_b32 v15, 15, v67, v15
  s_mov_b64 exec, 0xffffffff
  buffer_store_dwordx4 v[12:15], v1, s[12:15], s64 offen sc1
  s_mov_b64 exec, -1
  s_mov_b32 s74, 200000
L_pollq:
  buffer_load_dwordx4 v[32:35], v1, s[12:15], s66 offen offset:0 sc1
  buffer_load_dwordx4 v[36:39], v1, s[12:15], s66 offen offset:1024 sc1
  buffer_load_dwordx4 v[40:43], v1, s[12:15], s66 offen offset:2048 sc1
  buffer_load_dwordx4 v[44:47], v1, s[12:15], s66 offen offset:3072 sc1
  s_waitcnt vmcnt(0)
  v_xor_b32 v32, v64, v32
  v_xor_b32 v33, v65, v33
  v_xor_b32 v34, v66, v34
  v_xor_b32 v35, v67, v35
  v_xor_b32 v36, v64, v36
  v_xor_b32 v37, v65, v37
  v_xor_b32 v38, v66, v38
  v_xor_b32 v39, v67, v39
  v_xor_b32 v40, v64, v40
  v_xor_b32 v41, v65, v41
  v_xor_b32 v42, v66, v42
  v_xor_b32 v43, v67, v43
  v_xor_b32 v44, v64, v44
  v_xor_b32 v45, v65, v45
  v_xor_b32 v46, v66, v46
  v_xor_b32 v47, v67, v47
  v_or3_b32 v28, v32, v33, v34
  v_or3_b32 v29, v35, v36, v37
  v_or3_b32 v28, v28, v38, v39
  v_or3_b32 v29, v29, v40, v41
  v_or3_b32 v28, v28, v42, v43
  v_or3_b32 v29, v29, v44, v45
  v_or3_b32 v28, v28, v46, v47
  v_or_b32 v28, v28, v29
  v_and_b32 v28, 15, v28
  v_cmp_ne_u32 vcc, 0, v28
  s_cbranch_vccz L_pollq_done
  s_sleep 1
  s_sub_u32 s74, s74, 1
  s_cbranch_scc0 L_pollq
L_pollq_done:
  v_add_f32 v32, v32, v40
  v_add_f32 v33, v33, v41
  v_add_f32 v34, v34, v42
  v_add_f32 v35, v35, v43
  v_add_f32 v36, v36, v44
  v_add_f32 v37, v37, v45
  v_add_f32 v38, v38, v46
  v_add_f32 v39, v39, v47
  v_add_f32 v32, v32, v36
  v_add_f32 v33, v33, v37
  v_add_f32 v34, v34, v38
  v_add_f32 v35, v35, v39
  s_nop 1
  v_permlane32_swap_b32 v32, v34
  v_permlane32_swap_b32 v33, v35
  s_nop 0
  v_add_f32 v32, v32, v34
  v_add_f32 v33, v33, v35
  v_cvt_pk_bf16_f32 v32, v32, v33
  v_mov_b32 v30, 0
  v_mov_b32 v31, 1
  ds_write_b32 v25, v32 offset:0
  s_waitcnt lgkmcnt(0)
  ds_write_b32 v30, v31 offset:288
  s_branch L_svc2
L_loadtile:
  buffer_load_dwordx4 v[88:91], v24, s[40:43], s44 offen nt
  s_add_u32 s44, s44, s45
  buffer_load_dwordx4 v[92:95], v24, s[40:43], s44 offen nt
  s_add_u32 s44, s44, s45
  buffer_load_dwordx4 v[96:99], v24, s[40:43], s44 offen nt
  s_add_u32 s44, s44, s45
  buffer_load_dwordx4 v[100:103], v24, s[40:43], s44 offen nt
  s_add_u32 s44, s44, s45
  buffer_load_dwordx4 v[104:107], v24, s[40:43], s44 offen nt
  s_add_u32 s44, s44, s45
  buffer_load_dwordx4 v[108:111], v24, s[40:43], s44 offen nt
  s_add_u32 s44, s44, s45
  buffer_load_dwordx4 v[112:115], v24, s[40:43], s44 offen nt
  s_add_u32 s44, s44, s45
  buffer_load_dwordx4 v[116:119], v24, s[40:43], s44 offen nt
  s_add_u32 s44, s44, s45
  buffer_load_dwordx4 v[120:123], v24, s[40:43], s44 offen nt
  s_add_u32 s44, s44, s45
  buffer_load_dwordx4 v[124:127], v24, s[40:43], s44 offen nt
  s_add_u32 s44, s44, s45
  buffer_load_dwordx4 v[128:131], v24, s[40:43], s44 offen nt
  s_add_u32 s44, s44, s45
  buffer_load_dwordx4 v[132:135], v24, s[40:43], s44 offen nt
  s_add_u32 s44, s44, s45
  buffer_load_dwordx4 v[136:139], v24, s[40:43], s44 offen nt
  s_add_u32 s44, s44, s45
  buffer_load_dwordx4 v[140:143], v24, s[40:43], s44 offen nt
  s_add_u32 s44, s44, s45
  buffer_load_dwordx4 v[144:147], v24, s[40:43], s44 offen nt
  s_add_u32 s44, s44, s45
  buffer_load_dwordx4 v[148:151], v24, s[40:43], s44 offen nt
  s_add_u32 s44, s44, s45
  buffer_load_dwordx4 v[152:155], v24, s[40:43], s44 offen nt
  s_add_u32 s44, s44, s45
  buffer_load_dwordx4 v[156:159], v24, s[40:43], s44 offen nt
  s_add_u32 s44, s44, s45
  buffer_load_dwordx4 v[160:163], v24, s[40:43], s44 offen nt
  s_add_u32 s44, s44, s45
  buffer_load_dwordx4 v[164:167], v24, s[40:43], s44 offen nt
  s_add_u32 s44, s44, s45
  buffer_load_dwordx4 v[168:171], v24, s[40:43], s44 offen nt
  s_add_u32 s44, s44, s45
  buffer_load_dwordx4 v[172:175], v24, s[40:43], s44 offen nt
  s_add_u32 s44, s44, s45
  buffer_load_dwordx4 v[176:179], v24, s[40:43], s44 offen nt
  s_add_u32 s44, s44, s45
  buffer_load_dwordx4 v[180:183], v24, s[40:43], s44 offen nt
  s_add_u32 s44, s44, s45
  buffer_load_dwordx4 v[184:187], v24, s[40:43], s44 offen nt
  s_add_u32 s44, s44, s45
  buffer_load_dwordx4 v[188:191], v24, s[40:43], s44 offen nt
  s_add_u32 s44, s44, s45
  buffer_load_dwordx4 v[192:195], v24, s[40:43], s44 offen nt
  s_add_u32 s44, s44, s45
  buffer_load_dwordx4 v[196:199], v24, s[40:43], s44 offen nt
  s_add_u32 s44, s44, s45
  buffer_load_dwordx4 v[200:203], v24, s[40:43], s44 offen nt
  s_add_u32 s44, s44, s45
  buffer_load_dwordx4 v[204:207], v24, s[40:43], s44 offen nt
  s_add_u32 s44, s44, s45
  buffer_load_dwordx4 v[208:211], v24, s[40:43], s44 offen nt
  s_add_u32 s44, s44, s45
  buffer_load_dwordx4 v[212:215], v24, s[40:43], s44 offen nt
  s_setpc_b64 s[46:47]
L_matvec:
  s_nop 0
  v_and_b32_dpp v16, v8, v4 row_newbcast:0 row_mask:0xf bank_mask:0xf
  v_and_b32_dpp v17, v8, v5 row_newbcast:0 row_mask:0xf bank_mask:0xf
  v_and_b32_dpp v18, v8, v6 row_newbcast:0 row_mask:0xf bank_mask:0xf
  v_and_b32_dpp v19, v8, v7 row_newbcast:0 row_mask:0xf bank_mask:0xf
  v_and_b32_dpp v20, v9, v4 row_newbcast:0 row_mask:0xf bank_mask:0xf
  v_and_b32_dpp v21, v9, v5 row_newbcast:0 row_mask:0xf bank_mask:0xf
  v_and_b32_dpp v22, v9, v6 row_newbcast:0 row_mask:0xf bank_mask:0xf
  v_and_b32_dpp v23, v9, v7 row_newbcast:0 row_mask:0xf bank_mask:0xf
  v_mfma_f32_16x16x32_bf16 v[12:15], v[16:19], v[88:91], 0
  v_and_b32_dpp v16, v8, v4 row_newbcast:1 row_mask:0xf bank_mask:0xf
  v_and_b32_dpp v17, v8, v5 row_newbcast:1 row_mask:0xf bank_mask:0xf
  v_and_b32_dpp v18, v8, v6 row_newbcast:1 row_mask:0xf bank_mask:0xf
  v_and_b32_dpp v19, v8, v7 row_newbcast:1 row_mask:0xf bank_mask:0xf
  v_mfma_f32_16x16x32_bf16 v[12:15], v[20:23], v[92:95], v[12:15]
  v_and_b32_dpp v20, v9, v4 row_newbcast:1 row_mask:0xf bank_mask:0xf
  v_and_b32_dpp v21, v9, v5 row_newbcast:1 row_mask:0xf bank_mask:0xf
  v_and_b32_dpp v22, v9, v6 row_newbcast:1 row_mask:0xf bank_mask:0xf
  v_and_b32_dpp v23, v9, v7 row_newbcast:1 row_mask:0xf bank_mask:0xf
  v_mfma_f32_16x16x32_bf16 v[12:15], v[16:19], v[96:99], v[12:15]
  v_and_b32_dpp v16, v8, v4 row_newbcast:2 row_mask:0xf bank_mask:0xf
  v_and_b32_dpp v17, v8, v5 row_newbcast:2 row_mask:0xf bank_mask:0xf
  v_and_b32_dpp v18, v8, v6 row_newbcast:2 row_mask:0xf bank_mask:0xf
  v_and_b32_dpp v19, v8, v7 row_newbcast:2 row_mask:0xf bank_mask:0xf
  v_mfma_f32_16x16x32_bf16 v[12:15], v[20:23], v[100:103], v[12:15]
  v_and_b32_dpp v20, v9, v4 row_newbcast:2 row_mask:0xf bank_mask:0xf
  v_and_b32_dpp v21, v9, v5 row_newbcast:2 row_mask:0xf bank_mask:0xf
  v_and_b32_dpp v22, v9, v6 row_newbcast:2 row_mask:0xf bank_mask:0xf
  v_and_b32_dpp v23, v9, v7 row_newbcast:2 row_mask:0xf bank_mask:0xf
  v_mfma_f32_16x16x32_bf16 v[12:15], v[16:19], v[104:107], v[12:15]
  v_and_b32_dpp v16, v8, v4 row_newbcast:3 row_mask:0xf bank_mask:0xf
  v_and_b32_dpp v17, v8, v5 row_newbcast:3 row_mask:0xf bank_mask:0xf
  v_and_b32_dpp v18, v8, v6 row_newbcast:3 row_mask:0xf bank_mask:0xf
  v_and_b32_dpp v19, v8, v7 row_newbcast:3 row_mask:0xf bank_mask:0xf
  v_mfma_f32_16x16x32_bf16 v[12:15], v[20:23], v[108:111], v[12:15]
  v_and_b32_dpp v20, v9, v4 row_newbcast:3 row_mask:0xf bank_mask:0xf
  v_and_b32_dpp v21, v9, v5 row_newbcast:3 row_mask:0xf bank_mask:0xf
  v_and_b32_dpp v22, v9, v6 row_newbcast:3 row_mask:0xf bank_mask:0xf
  v_and_b32_dpp v23, v9, v7 row_newbcast:3 row_mask:0xf bank_mask:0xf
  v_mfma_f32_16x16x32_bf16 v[12:15], v[16:19], v[112:115], v[12:15]
  v_and_b32_dpp v16, v8, v4 row_newbcast:4 row_mask:0xf bank_mask:0xf
  v_and_b32_dpp v17, v8, v5 row_newbcast:4 row_mask:0xf bank_mask:0xf
  v_and_b32_dpp v18, v8, v6 row_newbcast:4 row_mask:0xf bank_mask:0xf
  v_and_b32_dpp v19, v8, v7 row_newbcast:4 row_mask:0xf bank_mask:0xf
  v_mfma_f32_16x16x32_bf16 v[12:15], v[20:23], v[116:119], v[12:15]
  v_and_b32_dpp v20, v9, v4 row_newbcast:4 row_mask:0xf bank_mask:0xf
  v_and_b32_dpp v21, v9, v5 row_newbcast:4 row_mask:0xf bank_mask:0xf
  v_and_b32_dpp v22, v9, v6 row_newbcast:4 row_mask:0xf bank_mask:0xf
  v_and_b32_dpp v23, v9, v7 row_newbcast:4 row_mask:0xf bank_mask:0xf
  v_mfma_f32_16x16x32_bf16 v[12:15], v[16:19], v[120:123], v[12:15]
  v_and_b32_dpp v16, v8, v4 row_newbcast:5 row_mask:0xf bank_mask:0xf
  v_and_b32_dpp v17, v8, v5 row_newbcast:5 row_mask:0xf bank_mask:0xf
  v_and_b32_dpp v18, v8, v6 row_newbcast:5 row_mask:0xf bank_mask:0xf
  v_and_b32_dpp v19, v8, v7 row_newbcast:5 row_mask:0xf bank_mask:0xf
  v_mfma_f32_16x16x32_bf16 v[12:15], v[20:23], v[124:127], v[12:15]
  v_and_b32_dpp v20, v9, v4 row_newbcast:5 row_mask:0xf bank_mask:0xf
  v_and_b32_dpp v21, v9, v5 row_newbcast:5 row_mask:0xf bank_mask:0xf
  v_and_b32_dpp v22, v9, v6 row_newbcast:5 row_mask:0xf bank_mask:0xf
  v_and_b32_dpp v23, v9, v7 row_newbcast:5 row_mask:0xf bank_mask:0xf
  v_mfma_f32_16x16x32_bf16 v[12:15], v[16:19], v[128:131], v[12:15]
  v_and_b32_dpp v16, v8, v4 row_newbcast:6 row_mask:0xf bank_mask:0xf
  v_and_b32_dpp v17, v8, v5 row_newbcast:6 row_mask:0xf bank_mask:0xf
  v_and_b32_dpp v18, v8, v6 row_newbcast:6 row_mask:0xf bank_mask:0xf
  v_and_b32_dpp v19, v8, v7 row_newbcast:6 row_mask:0xf bank_mask:0xf
  v_mfma_f32_16x16x32_bf16 v[12:15], v[20:23], v[132:135], v[12:15]
  v_and_b32_dpp v20, v9, v4 row_newbcast:6 row_mask:0xf bank_mask:0xf
  v_and_b32_dpp v21, v9, v5 row_newbcast:6 row_mask:0xf bank_mask:0xf
  v_and_b32_dpp v22, v9, v6 row_newbcast:6 row_mask:0xf bank_mask:0xf
  v_and_b32_dpp v23, v9, v7 row_newbcast:6 row_mask:0xf bank_mask:0xf
  v_mfma_f32_16x16x32_bf16 v[12:15], v[16:19], v[136:139], v[12:15]
  v_and_b32_dpp v16, v8, v4 row_newbcast:7 row_mask:0xf bank_mask:0xf
  v_and_b32_dpp v17, v8, v5 row_newbcast:7 row_mask:0xf bank_mask:0xf
  v_and_b32_dpp v18, v8, v6 row_newbcast:7 row_mask:0xf bank_mask:0xf
  v_and_b32_dpp v19, v8, v7 row_newbcast:7 row_mask:0xf bank_mask:0xf
  v_mfma_f32_16x16x32_bf16 v[12:15], v[20:23], v[140:143], v[12:15]
  v_and_b32_dpp v20, v9, v4 row_newbcast:7 row_mask:0xf bank_mask:0xf
  v_and_b32_dpp v21, v9, v5 row_newbcast:7 row_mask:0xf bank_mask:0xf
  v_and_b32_dpp v22, v9, v6 row_newbcast:7 row_mask:0xf bank_mask:0xf
  v_and_b32_dpp v23, v9, v7 row_newbcast:7 row_mask:0xf bank_mask:0xf
  v_mfma_f32_16x16x32_bf16 v[12:15], v[16:19], v[144:147], v[12:15]
  v_and_b32_dpp v16, v8, v4 row_newbcast:8 row_mask:0xf bank_mask:0xf
  v_and_b32_dpp v17, v8, v5 row_newbcast:8 row_mask:0xf bank_mask:0xf
  v_and_b32_dpp v18, v8, v6 row_newbcast:8 row_mask:0xf bank_mask:0xf
  v_and_b32_dpp v19, v8, v7 row_newbcast:8 row_mask:0xf bank_mask:0xf
  v_mfma_f32_16x16x32_bf16 v[12:15], v[20:23], v[148:151], v[12:15]
  v_and_b32_dpp v20, v9, v4 row_newbcast:8 row_mask:0xf bank_mask:0xf
  v_and_b32_dpp v21, v9, v5 row_newbcast:8 row_mask:0xf bank_mask:0xf
  v_and_b32_dpp v22, v9, v6 row_newbcast:8 row_mask:0xf bank_mask:0xf
  v_and_b32_dpp v23, v9, v7 row_newbcast:8 row_mask:0xf bank_mask:0xf
  v_mfma_f32_16x16x32_bf16 v[12:15], v[16:19], v[152:155], v[12:15]
  v_and_b32_dpp v16, v8, v4 row_newbcast:9 row_mask:0xf bank_mask:0xf
  v_and_b32_dpp v17, v8, v5 row_newbcast:9 row_mask:0xf bank_mask:0xf
  v_and_b32_dpp v18, v8, v6 row_newbcast:9 row_mask:0xf bank_mask:0xf
  v_and_b32_dpp v19, v8, v7 row_newbcast:9 row_mask:0xf bank_mask:0xf
  v_mfma_f32_16x16x32_bf16 v[12:15], v[20:23], v[156:159], v[12:15]
  v_and_b32_dpp v20, v9, v4 row_newbcast:9 row_mask:0xf bank_mask:0xf
  v_and_b32_dpp v21, v9, v5 row_newbcast:9 row_mask:0xf bank_mask:0xf
  v_and_b32_dpp v22, v9, v6 row_newbcast:9 row_mask:0xf bank_mask:0xf
  v_and_b32_dpp v23, v9, v7 row_newbcast:9 row_mask:0xf bank_mask:0xf
  v_mfma_f32_16x16x32_bf16 v[12:15], v[16:19], v[160:163], v[12:15]
  v_and_b32_dpp v16, v8, v4 row_newbcast:10 row_mask:0xf bank_mask:0xf
  v_and_b32_dpp v17, v8, v5 row_newbcast:10 row_mask:0xf bank_mask:0xf
  v_and_b32_dpp v18, v8, v6 row_newbcast:10 row_mask:0xf bank_mask:0xf
  v_and_b32_dpp v19, v8, v7 row_newbcast:10 row_mask:0xf bank_mask:0xf
  v_mfma_f32_16x16x32_bf16 v[12:15], v[20:23], v[164:167], v[12:15]
  v_and_b32_dpp v20, v9, v4 row_newbcast:10 row_mask:0xf bank_mask:0xf
  v_and_b32_dpp v21, v9, v5 row_newbcast:10 row_mask:0xf bank_mask:0xf
  v_and_b32_dpp v22, v9, v6 row_newbcast:10 row_mask:0xf bank_mask:0xf
  v_and_b32_dpp v23, v9, v7 row_newbcast:10 row_mask:0xf bank_mask:0xf
  v_mfma_f32_16x16x32_bf16 v[12:15], v[16:19], v[168:171], v[12:15]
  v_and_b32_dpp v16, v8, v4 row_newbcast:11 row_mask:0xf bank_mask:0xf
  v_and_b32_dpp v17, v8, v5 row_newbcast:11 row_mask:0xf bank_mask:0xf
  v_and_b32_dpp v18, v8, v6 row_newbcast:11 row_mask:0xf bank_mask:0xf
  v_and_b32_dpp v19, v8, v7 row_newbcast:11 row_mask:0xf bank_mask:0xf
  v_mfma_f32_16x16x32_bf16 v[12:15], v[20:23], v[172:175], v[12:15]
  v_and_b32_dpp v20, v9, v4 row_newbcast:11 row_mask:0xf bank_mask:0xf
  v_and_b32_dpp v21, v9, v5 row_newbcast:11 row_mask:0xf bank_mask:0xf
  v_and_b32_dpp v22, v9, v6 row_newbcast:11 row_mask:0xf bank_mask:0xf
  v_and_b32_dpp v23, v9, v7 row_newbcast:11 row_mask:0xf bank_mask:0xf
  v_mfma_f32_16x16x32_bf16 v[12:15], v[16:19], v[176:179], v[12:15]
  v_and_b32_dpp v16, v8, v4 row_newbcast:12 row_mask:0xf bank_mask:0xf
  v_and_b32_dpp v17, v8, v5 row_newbcast:12 row_mask:0xf bank_mask:0xf
  v_and_b32_dpp v18, v8, v6 row_newbcast:12 row_mask:0xf bank_mask:0xf
  v_and_b32_dpp v19, v8, v7 row_newbcast:12 row_mask:0xf bank_mask:0xf
  v_mfma_f32_16x16x32_bf16 v[12:15], v[20:23], v[180:183], v[12:15]
  v_and_b32_dpp v20, v9, v4 row_newbcast:12 row_mask:0xf bank_mask:0xf
  v_and_b32_dpp v21, v9, v5 row_newbcast:12 row_mask:0xf bank_mask:0xf
  v_and_b32_dpp v22, v9, v6 row_newbcast:12 row_mask:0xf bank_mask:0xf
  v_and_b32_dpp v23, v9, v7 row_newbcast:12 row_mask:0xf bank_mask:0xf
  v_mfma_f32_16x16x32_bf16 v[12:15], v[16:19], v[184:187], v[12:15]
  v_and_b32_dpp v16, v8, v4 row_newbcast:13 row_mask:0xf bank_mask:0xf
  v_and_b32_dpp v17, v8, v5 row_newbcast:13 row_mask:0xf bank_mask:0xf
  v_and_b32_dpp v18, v8, v6 row_newbcast:13 row_mask:0xf bank_mask:0xf
  v_and_b32_dpp v19, v8, v7 row_newbcast:13 row_mask:0xf bank_mask:0xf
  v_mfma_f32_16x16x32_bf16 v[12:15], v[20:23], v[188:191], v[12:15]
  v_and_b32_dpp v20, v9, v4 row_newbcast:13 row_mask:0xf bank_mask:0xf
  v_and_b32_dpp v21, v9, v5 row_newbcast:13 row_mask:0xf bank_mask:0xf
  v_and_b32_dpp v22, v9, v6 row_newbcast:13 row_mask:0xf bank_mask:0xf
  v_and_b32_dpp v23, v9, v7 row_newbcast:13 row_mask:0xf bank_mask:0xf
  v_mfma_f32_16x16x32_bf16 v[12:15], v[16:19], v[192:195], v[12:15]
  v_and_b32_dpp v16, v8, v4 row_newbcast:14 row_mask:0xf bank_mask:0xf
  v_and_b32_dpp v17, v8, v5 row_newbcast:14 row_mask:0xf bank_mask:0xf
  v_and_b32_dpp v18, v8, v6 row_newbcast:14 row_mask:0xf bank_mask:0xf
  v_and_b32_dpp v19, v8, v7 row_newbcast:14 row_mask:0xf bank_mask:0xf
  v_mfma_f32_16x16x32_bf16 v[12:15], v[20:23], v[196:199], v[12:15]
  v_and_b32_dpp v20, v9, v4 row_newbcast:14 row_mask:0xf bank_mask:0xf
  v_and_b32_dpp v21, v9, v5 row_newbcast:14 row_mask:0xf bank_mask:0xf
  v_and_b32_dpp v22, v9, v6 row_newbcast:14 row_mask:0xf bank_mask:0xf
  v_and_b32_dpp v23, v9, v7 row_newbcast:14 row_mask:0xf bank_mask:0xf
  v_mfma_f32_16x16x32_bf16 v[12:15], v[16:19], v[200:203], v[12:15]
  v_and_b32_dpp v16, v8, v4 row_newbcast:15 row_mask:0xf bank_mask:0xf
  v_and_b32_dpp v17, v8, v5 row_newbcast:15 row_mask:0xf bank_mask:0xf
  v_and_b32_dpp v18, v8, v6 row_newbcast:15 row_mask:0xf bank_mask:0xf
  v_and_b32_dpp v19, v8, v7 row_newbcast:15 row_mask:0xf bank_mask:0xf
  v_mfma_f32_16x16x32_bf16 v[12:15], v[20:23], v[204:207], v[12:15]
  v_and_b32_dpp v20, v9, v4 row_newbcast:15 row_mask:0xf bank_mask:0xf
  v_and_b32_dpp v21, v9, v5 row_newbcast:15 row_mask:0xf bank_mask:0xf
  v_and_b32_dpp v22, v9, v6 row_newbcast:15 row_mask:0xf bank_mask:0xf
  v_and_b32_dpp v23, v9, v7 row_newbcast:15 row_mask:0xf bank_mask:0xf
  v_mfma_f32_16x16x32_bf16 v[12:15], v[16:19], v[208:211], v[12:15]
  s_nop 1
  v_mfma_f32_16x16x32_bf16 v[12:15], v[20:23], v[212:215], v[12:15]
  s_nop 6
  s_setpc_b64 s[46:47]
L_str2:
L_waitq:
  s_sleep 1
  ds_read_b32 v19, v52 offset:288
  s_waitcnt lgkmcnt(0)
  v_cmp_gt_u32 vcc, 1, v19
  s_cbranch_vccnz L_waitq
  ds_read_b128 v[8:11], v3 offset:0
  v_mov_b32 v16, 0xff7fffff
  s_waitcnt lgkmcnt(0)
  s_call_b64 s[78:79], L_bodyA
  s_call_b64 s[78:79], L_bodyX
  s_call_b64 s[78:79], L_bodyA
  v_mov_b32 v88, v120
  v_mov_b32 v89, v121
  v_mov_b32 v90, v122
  v_mov_b32 v91, v123
  v_mov_b32 v92, v124
  v_mov_b32 v93, v125
  v_mov_b32 v94, v126
  v_mov_b32 v95, v127
  v_mov_b32 v96, v128
  v_mov_b32 v97, v129
  v_mov_b32 v98, v130
  v_mov_b32 v99, v131
  v_mov_b32 v100, v132
  v_mov_b32 v101, v133
  v_mov_b32 v102, v134
  v_mov_b32 v103, v135
  v_mov_b32 v104, v136
  v_mov_b32 v105, v137
  v_mov_b32 v106, v138
  v_mov_b32 v107, v139
  v_mov_b32 v108, v140
  v_mov_b32 v109, v141
  v_mov_b32 v110, v142
  v_mov_b32 v111, v143
  v_mov_b32 v112, v144
  v_mov_b32 v113, v145
  v_mov_b32 v114, v146
  v_mov_b32 v115, v147
  v_mov_b32 v116, v148
  v_mov_b32 v117, v149
  v_mov_b32 v118, v150
  v_mov_b32 v119, v151
  s_call_b64 s[78:79], L_bodyX
  s_call_b64 s[78:79], L_bodyA
  v_mov_b32 v88, v152
  v_mov_b32 v89, v153
  v_mov_b32 v90, v154
  v_mov_b32 v91, v155
  v_mov_b32 v92, v156
  v_mov_b32 v93, v157
  v_mov_b32 v94, v158
  v_mov_b32 v95, v159
  v_mov_b32 v96, v160
  v_mov_b32 v97, v161
  v_mov_b32 v98, v162
  v_mov_b32 v99, v163
  v_mov_b32 v100, v164
  v_mov_b32 v101, v165
  v_mov_b32 v102, v166
  v_mov_b32 v103, v167
  v_mov_b32 v104, v168
  v_mov_b32 v105, v169
  v_mov_b32 v106, v170
  v_mov_b32 v107, v171
  v_mov_b32 v108, v172
  v_mov_b32 v109, v173
  v_mov_b32 v110, v174
  v_mov_b32 v111, v175
  v_mov_b32 v112, v176
  v_mov_b32 v113, v177
  v_mov_b32 v114, v178
  v_mov_b32 v115, v179
  v_mov_b32 v116, v180
  v_mov_b32 v117, v181
  v_mov_b32 v118, v182
  v_mov_b32 v119, v183
  s_call_b64 s[78:79], L_bodyX
  s_branch L_loopA
L_bodyX:
  v_dot2_f32_bf16 v20, v88, v8, 0
  v_dot2_f32_bf16 v21, v92, v8, 0
  v_dot2_f32_bf16 v22, v96, v8, 0
  v_dot2_f32_bf16 v23, v100, v8, 0
  v_dot2_f32_bf16 v20, v89, v9, v20
  v_dot2_f32_bf16 v21, v93, v9, v21
  v_dot2_f32_bf16 v22, v97, v9, v22
  v_dot2_f32_bf16 v23, v101, v9, v23
  v_dot2_f32_bf16 v20, v90, v10, v20
  v_dot2_f32_bf16 v21, v94, v10, v21
  v_dot2_f32_bf16 v22, v98, v10, v22
  v_dot2_f32_bf16 v23, v102, v10, v23
  v_dot2_f32_bf16 v20, v91, v11, v20
  v_dot2_f32_bf16 v21, v95, v11, v21
  v_dot2_f32_bf16 v22, v99, v11, v22
  v_dot2_f32_bf16 v23, v103, v11, v23
  s_nop 1
  v_add_f32_dpp v20, v20, v20 row_ror:8 row_mask:0xf bank_mask:0xf
  v_add_f32_dpp v21, v21, v21 row_ror:8 row_mask:0xf bank_mask:0xf
  v_add_f32_dpp v22, v22, v22 row_ror:8 row_mask:0xf bank_mask:0xf
  v_add_f32_dpp v23, v23, v23 row_ror:8 row_mask:0xf bank_mask:0xf
  v_add_f32_dpp v20, v20, v20 row_ror:4 row_mask:0xf bank_mask:0xf
  v_add_f32_dpp v21, v21, v21 row_ror:4 row_mask:0xf bank_mask:0xf
  v_add_f32_dpp v22, v22, v22 row_ror:4 row_mask:0xf bank_mask:0xf
  v_add_f32_dpp v23, v23, v23 row_ror:4 row_mask:0xf bank_mask:0xf
  v_add_f32_dpp v20, v20, v20 row_ror:2 row_mask:0xf bank_mask:0xf
  v_add_f32_dpp v21, v21, v21 row_ror:2 row_mask:0xf bank_mask:0xf
  v_add_f32_dpp v22, v22, v22 row_ror:2 row_mask:0xf bank_mask:0xf
  v_add_f32_dpp v23, v23, v23 row_ror:2 row_mask:0xf bank_mask:0xf
  v_add_f32_dpp v20, v20, v20 row_ror:1 row_mask:0xf bank_mask:0xf
  v_add_f32_dpp v21, v21, v21 row_ror:1 row_mask:0xf bank_mask:0xf
  v_add_f32_dpp v22, v22, v22 row_ror:1 row_mask:0xf bank_mask:0xf
  v_add_f32_dpp v23, v23, v23 row_ror:1 row_mask:0xf bank_mask:0xf
  v_cvt_pk_bf16_f32 v28, v20, v21
  v_cvt_pk_bf16_f32 v29, v22, v23
  v_lshlrev_b32 v20, 16, v28
  v_and_b32 v21, s7, v28
  v_lshlrev_b32 v22, 16, v29
  v_and_b32 v23, s7, v29
  v_mul_f32 v20, s8, v20
  v_mul_f32 v21, s8, v21
  v_mul_f32 v22, s8, v22
  v_mul_f32 v23, s8, v23
  v_cvt_pk_bf16_f32 v28, v20, v21
  v_cvt_pk_bf16_f32 v29, v22, v23
  v_max3_f32 v16, v16, v20, v21
  v_max3_f32 v16, v16, v22, v23
  v_dot2_f32_bf16 v20, v104, v8, 0
  v_dot2_f32_bf16 v21, v108, v8, 0
  v_dot2_f32_bf16 v22, v112, v8, 0
  v_dot2_f32_bf16 v23, v116, v8, 0
  v_dot2_f32_bf16 v20, v105, v9, v20
  v_dot2_f32_bf16 v21, v109, v9, v21
  v_dot2_f32_bf16 v22, v113, v9, v22
  v_dot2_f32_bf16 v23, v117, v9, v23
  v_dot2_f32_bf16 v20, v106, v10, v20
  v_dot2_f32_bf16 v21, v110, v10, v21
  v_dot2_f32_bf16 v22, v114, v10, v22
  v_dot2_f32_bf16 v23, v118, v10, v23
  v_dot2_f32_bf16 v20, v107, v11, v20
  v_dot2_f32_bf16 v21, v111, v11, v21
  v_dot2_f32_bf16 v22, v115, v11, v22
  v_dot2_f32_bf16 v23, v119, v11, v23
  s_nop 1
  v_add_f32_dpp v20, v20, v20 row_ror:8 row_mask:0xf bank_mask:0xf
  v_add_f32_dpp v21, v21, v21 row_ror:8 row_mask:0xf bank_mask:0xf
  v_add_f32_dpp v22, v22, v22 row_ror:8 row_mask:0xf bank_mask:0xf
  v_add_f32_dpp v23, v23, v23 row_ror:8 row_mask:0xf bank_mask:0xf
  v_add_f32_dpp v20, v20, v20 row_ror:4 row_mask:0xf bank_mask:0xf
  v_add_f32_dpp v21, v21, v21 row_ror:4 row_mask:0xf bank_mask:0xf
  v_add_f32_dpp v22, v22, v22 row_ror:4 row_mask:0xf bank_mask:0xf
  v_add_f32_dpp v23, v23, v23 row_ror:4 row_mask:0xf bank_mask:0xf
  v_add_f32_dpp v20, v20, v20 row_ror:2 row_mask:0xf bank_mask:0xf
  v_add_f32_dpp v21, v21, v21 row_ror:2 row_mask:0xf bank_mask:0xf
  v_add_f32_dpp v22, v22, v22 row_ror:2 row_mask:0xf bank_mask:0xf
  v_add_f32_dpp v23, v23, v23 row_ror:2 row_mask:0xf bank_mask:0xf
  v_add_f32_dpp v20, v20, v20 row_ror:1 row_mask:0xf bank_mask:0xf
  v_add_f32_dpp v21, v21, v21 row_ror:1 row_mask:0xf bank_mask:0xf
  v_add_f32_dpp v22, v22, v22 row_ror:1 row_mask:0xf bank_mask:0xf
  v_add_f32_dpp v23, v23, v23 row_ror:1 row_mask:0xf bank_mask:0xf
  v_cvt_pk_bf16_f32 v30, v20, v21
  v_cvt_pk_bf16_f32 v31, v22, v23
  v_lshlrev_b32 v20, 16, v30
  v_and_b32 v21, s7, v30
  v_lshlrev_b32 v22, 16, v31
  v_and_b32 v23, s7, v31
  v_mul_f32 v20, s8, v20
  v_mul_f32 v21, s8, v21
  v_mul_f32 v22, s8, v22
  v_mul_f32 v23, s8, v23
  v_cvt_pk_bf16_f32 v30, v20, v21
  v_cvt_pk_bf16_f32 v31, v22, v23
  v_max3_f32 v16, v16, v20, v21
  v_max3_f32 v16, v16, v22, v23
  s_mov_b64 exec, s[76:77]
  ds_write_b128 v55, v[28:31]
  s_mov_b64 exec, -1
  v_add_u32 v55, 256, v55
  s_setpc_b64 s[78:79]
.p2align 6
L_bodyA:
  ds_read_b32 v32, v52 offset:312
  v_mov_b32 v34, s63
  s_cmp_eq_u32 s63, 64
  s_cselect_b32 s70, 1, s70
  s_cselect_b64 s[40:41], s[50:51], s[40:41]
  s_add_u32 s70, s70, 1
  s_xor_b32 s64, s70, s73
  s_bfe_u32 s65, s64, 65536
  s_lshl_b32 s65, s65, 16
  s_add_u32 s52, s62, s65
  s_bfe_u32 s65, s64, 65537
  s_lshl_b32 s65, s65, 10
  s_add_u32 s52, s52, s65
  s_bfe_u32 s65, s64, 262146
  s_lshl_b32 s65, s65, 17
  s_add_u32 s52, s52, s65
  s_add_u32 s53, s52, 8192
  s_add_u32 s66, s52, 16384
  s_add_u32 s67, s52, 24576
  s_add_u32 s63, s63, 1
  s_waitcnt vmcnt(4)
  v_dot2_f32_bf16 v20, v56, v8, 0
  v_dot2_f32_bf16 v21, v60, v8, 0
  v_dot2_f32_bf16 v22, v64, v8, 0
  v_dot2_f32_bf16 v23, v68, v8, 0
  v_dot2_f32_bf16 v20, v57, v9, v20
  v_dot2_f32_bf16 v21, v61, v9, v21
  v_dot2_f32_bf16 v22, v65, v9, v22
  v_dot2_f32_bf16 v23, v69, v9, v23
  v_dot2_f32_bf16 v20, v58, v10, v20
  v_dot2_f32_bf16 v21, v62, v10, v21
  v_dot2_f32_bf16 v22, v66, v10, v22
  v_dot2_f32_bf16 v23, v70, v10, v23
  v_dot2_f32_bf16 v20, v59, v11, v20
  v_dot2_f32_bf16 v21, v63, v11, v21
  v_dot2_f32_bf16 v22, v67, v11, v22
  v_dot2_f32_bf16 v23, v71, v11, v23
  buffer_load_dwordx4 v[56:59], v1, s[40:43], s52 offen offset:0 nt
  s_cmp_eq_u32 s61, 1
  s_cbranch_scc1 L_e1
  buffer_load_dwordx4 v[60:63], v1, s[40:43], s53 offen offset:0 nt
L_e1:
  v_add_f32_dpp v20, v20, v20 row_ror:8 row_mask:0xf bank_mask:0xf
  v_add_f32_dpp v21, v21, v21 row_ror:8 row_mask:0xf bank_mask:0xf
  v_add_f32_dpp v22, v22, v22 row_ror:8 row_mask:0xf bank_mask:0xf
  v_add_f32_dpp v23, v23, v23 row_ror:8 row_mask:0xf bank_mask:0xf
  v_add_f32_dpp v20, v20, v20 row_ror:4 row_mask:0xf bank_mask:0xf
  v_add_f32_dpp v21, v21, v21 row_ror:4 row_mask:0xf bank_mask:0xf
  v_add_f32_dpp v22, v22, v22 row_ror:4 row_mask:0xf bank_mask:0xf
  v_add_f32_dpp v23, v23, v23 row_ror:4 row_mask:0xf bank_mask:0xf
  v_add_f32_dpp v20, v20, v20 row_ror:2 row_mask:0xf bank_mask:0xf
  v_add_f32_dpp v21, v21, v21 row_ror:2 row_mask:0xf bank_mask:0xf
  v_add_f32_dpp v22, v22, v22 row_ror:2 row_mask:0xf bank_mask:0xf
  v_add_f32_dpp v23, v23, v23 row_ror:2 row_mask:0xf bank_mask:0xf
  v_add_f32_dpp v20, v20, v20 row_ror:1 row_mask:0xf bank_mask:0xf
  v_add_f32_dpp v21, v21, v21 row_ror:1 row_mask:0xf bank_mask:0xf
  v_add_f32_dpp v22, v22, v22 row_ror:1 row_mask:0xf bank_mask:0xf
  v_add_f32_dpp v23, v23, v23 row_ror:1 row_mask:0xf bank_mask:0xf
  v_cvt_pk_bf16_f32 v28, v20, v21
  v_cvt_pk_bf16_f32 v29, v22, v23
  v_lshlrev_b32 v20, 16, v28
  v_and_b32 v21, s7, v28
  v_lshlrev_b32 v22, 16, v29
  v_and_b32 v23, s7, v29
  v_mul_f32 v20, s8, v20
  v_mul_f32 v21, s8, v21
  v_mul_f32 v22, s8, v22
  v_mul_f32 v23, s8, v23
  v_cvt_pk_bf16_f32 v28, v20, v21
  v_cvt_pk_bf16_f32 v29, v22, v23
  v_max3_f32 v16, v16, v20, v21
  v_max3_f32 v16, v16, v22, v23
  s_cmp_eq_u32 s61, 1
  s_cbranch_scc1 L_l2s
  s_cmp_eq_u32 s61, 2
  s_cbranch_scc1 L_l2b
  s_waitcnt vmcnt(4)
  buffer_load_dwordx4 v[64:67], v1, s[40:43], s66 offen offset:0 nt
  s_waitcnt vmcnt(4)
  buffer_load_dwordx4 v[68:71], v1, s[40:43], s67 offen offset:0 nt
  s_branch L_l2x
L_l2s:
  s_waitcnt vmcnt(4)
  buffer_load_dwordx4 v[60:63], v1, s[40:43], s53 offen offset:0 nt
  s_waitcnt vmcnt(4)
  buffer_load_dwordx4 v[64:67], v1, s[40:43], s66 offen offset:0 nt
  s_waitcnt vmcnt(4)
  buffer_load_dwordx4 v[68:71], v1, s[40:43], s67 offen offset:0 nt
  s_branch L_l2x
L_l2b:
  s_waitcnt vmcnt(5)
  buffer_load_dwordx4 v[64:67], v1, s[40:43], s66 offen offset:0 nt
  buffer_load_dwordx4 v[68:71], v1, s[40:43], s67 offen offset:0 nt
L_l2x:
  s_waitcnt vmcnt(4)
  v_dot2_f32_bf16 v20, v72, v8, 0
  v_dot2_f32_bf16 v21, v76, v8, 0
  v_dot2_f32_bf16 v22, v80, v8, 0
  v_dot2_f32_bf16 v23, v84, v8, 0
  v_dot2_f32_bf16 v20, v73, v9, v20
  v_dot2_f32_bf16 v21, v77, v9, v21
  v_dot2_f32_bf16 v22, v81, v9, v22
  v_dot2_f32_bf16 v23, v85, v9, v23
  v_dot2_f32_bf16 v20, v74, v10, v20
  v_dot2_f32_bf16 v21, v78, v10, v21
  v_dot2_f32_bf16 v22, v82, v10, v22
  v_dot2_f32_bf16 v23, v86, v10, v23
  v_dot2_f32_bf16 v20, v75, v11, v20
  v_dot2_f32_bf16 v21, v79, v11, v21
  v_dot2_f32_bf16 v22, v83, v11, v22
  v_dot2_f32_bf16 v23, v87, v11, v23
  buffer_load_dwordx4 v[72:75], v1, s[40:43], s52 offen offset:2048 nt
  s_cmp_eq_u32 s61, 1
  s_cbranch_scc1 L_e3
  buffer_load_dwordx4 v[76:79], v1, s[40:43], s53 offen offset:2048 nt
L_e3:
  v_add_f32_dpp v20, v20, v20 row_ror:8 row_mask:0xf bank_mask:0xf
  v_add_f32_dpp v21, v21, v21 row_ror:8 row_mask:0xf bank_mask:0xf
  v_add_f32_dpp v22, v22, v22 row_ror:8 row_mask:0xf bank_mask:0xf
  v_add_f32_dpp v23, v23, v23 row_ror:8 row_mask:0xf bank_mask:0xf
  v_add_f32_dpp v20, v20, v20 row_ror:4 row_mask:0xf bank_mask:0xf
  v_add_f32_dpp v21, v21, v21 row_ror:4 row_mask:0xf bank_mask:0xf
  v_add_f32_dpp v22, v22, v22 row_ror:4 row_mask:0xf bank_mask:0xf
  v_add_f32_dpp v23, v23, v23 row_ror:4 row_mask:0xf bank_mask:0xf
  v_add_f32_dpp v20, v20, v20 row_ror:2 row_mask:0xf bank_mask:0xf
  v_add_f32_dpp v21, v21, v21 row_ror:2 row_mask:0xf bank_mask:0xf
  v_add_f32_dpp v22, v22, v22 row_ror:2 row_mask:0xf bank_mask:0xf
  v_add_f32_dpp v23, v23, v23 row_ror:2 row_mask:0xf bank_mask:0xf
  v_add_f32_dpp v20, v20, v20 row_ror:1 row_mask:0xf bank_mask:0xf
  v_add_f32_dpp v21, v21, v21 row_ror:1 row_mask:0xf bank_mask:0xf
  v_add_f32_dpp v22, v22, v22 row_ror:1 row_mask:0xf bank_mask:0xf
  v_add_f32_dpp v23, v23, v23 row_ror:1 row_mask:0xf bank_mask:0xf
  v_cvt_pk_bf16_f32 v30, v20, v21
  v_cvt_pk_bf16_f32 v31, v22, v23
  v_lshlrev_b32 v20, 16, v30
  v_and_b32 v21, s7, v30
  v_lshlrev_b32 v22, 16, v31
  v_and_b32 v23, s7, v31
  v_mul_f32 v20, s8, v20
  v_mul_f32 v21, s8, v21
  v_mul_f32 v22, s8, v22
  v_mul_f32 v23, s8, v23
  v_cvt_pk_bf16_f32 v30, v20, v21
  v_cvt_pk_bf16_f32 v31, v22, v23
  v_max3_f32 v16, v16, v20, v21
  v_max3_f32 v16, v16, v22, v23
  s_cmp_eq_u32 s61, 1
  s_cbranch_scc1 L_l4s
  s_cmp_eq_u32 s61, 2
  s_cbranch_scc1 L_l4b
  s_waitcnt vmcnt(4)
  buffer_load_dwordx4 v[80:83], v1, s[40:43], s66 offen offset:2048 nt
  s_waitcnt vmcnt(4)
  buffer_load_dwordx4 v[84:87], v1, s[40:43], s67 offen offset:2048 nt
  s_branch L_l4x
L_l4s:
  s_waitcnt vmcnt(4)
  buffer_load_dwordx4 v[76:79], v1, s[40:43], s53 offen offset:2048 nt
  s_waitcnt vmcnt(4)
  buffer_load_dwordx4 v[80:83], v1, s[40:43], s66 offen offset:2048 nt
  s_waitcnt vmcnt(4)
  buffer_load_dwordx4 v[84:87], v1, s[40:43], s67 offen offset:2048 nt
  s_branch L_l4x
L_l4b:
  s_waitcnt vmcnt(5)
  buffer_load_dwordx4 v[80:83], v1, s[40:43], s66 offen offset:2048 nt
  buffer_load_dwordx4 v[84:87], v1, s[40:43], s67 offen offset:2048 nt
L_l4x:
  s_waitcnt lgkmcnt(0)
  v_readfirstlane_b32 s61, v32
  s_mov_b64 exec, s[76:77]
  ds_write_b128 v53, v[28:31]
  ds_write_b32 v33, v34 offset:320
  s_mov_b64 exec, -1
  v_add_u32 v53, 256, v53
  s_setpc_b64 s[78:79]
L_loopA:
  s_call_b64 s[78:79], L_bodyA
  s_cmp_le_u32 s63, 64
  s_cbranch_scc1 L_loopA
  v_mov_b32 v18, 1
  s_mov_b64 exec, 1
  ds_add_u32 v52, v18 offset:292
  s_mov_b64 exec, -1
  v_mov_b32 v19, v16
  s_nop 1
  v_permlane32_swap_b32 v16, v19
  s_nop 0
  v_max_f32 v16, v16, v19
  v_mov_b32 v19, v16
  s_nop 1
  v_permlane16_swap_b32 v16, v19
  s_nop 0
  v_max_f32 v16, v16, v19
  v_cvt_pk_bf16_f32 v16, v16, v16
  v_and_b32 v16, s7, v16
  v_max_f32 v16, 0xff7fffff, v16
  s_add_u32 s72, s72, 512
  v_add_u32 v53, s72, v54
  s_mov_b32 s68, 62
  s_mov_b32 s9, 0
.p2align 6
L_loopV:
  ds_read_b128 v[28:31], v53
  s_cmp_le_u32 s68, 1
  s_cbranch_scc1 L_ticket
  ds_read_b32 v32, v52 offset:312
  s_sub_u32 s64, 126, s68
  v_mov_b32 v34, s64
  s_mov_b64 exec, 1
  ds_write_b32 v33, v34 offset:320
  s_mov_b64 exec, -1
  v_add_u32 v53, 256, v53
  s_add_u32 s70, s70, 1
  s_xor_b32 s64, s70, s73
  s_bfe_u32 s65, s64, 65536
  s_lshl_b32 s65, s65, 16
  s_add_u32 s52, s62, s65
  s_bfe_u32 s65, s64, 65537
  s_lshl_b32 s65, s65, 10
  s_add_u32 s52, s52, s65
  s_bfe_u32 s65, s64, 262146
  s_lshl_b32 s65, s65, 17
  s_add_u32 s52, s52, s65
  s_add_u32 s53, s52, 8192
  s_add_u32 s66, s52, 16384
  s_add_u32 s67, s52, 24576
  s_sub_u32 s68, s68, 1
  s_waitcnt lgkmcnt(0)
  v_readfirstlane_b32 s61, v32
  v_lshlrev_b32 v20, 16, v28
  v_and_b32 v21, s7, v28
  v_lshlrev_b32 v22, 16, v29
  v_and_b32 v23, s7, v29
  v_lshlrev_b32 v24, 16, v30
  v_and_b32 v25, s7, v30
  v_lshlrev_b32 v26, 16, v31
  v_and_b32 v27, s7, v31
L_back_v:
  v_sub_f32 v20, v20, v16
  v_sub_f32 v21, v21, v16
  v_sub_f32 v22, v22, v16
  v_sub_f32 v23, v23, v16
  v_sub_f32 v24, v24, v16
  v_sub_f32 v25, v25, v16
  v_sub_f32 v26, v26, v16
  v_sub_f32 v27, v27, v16
  v_mul_f32 v20, s6, v20
  v_mul_f32 v21, s6, v21
  v_mul_f32 v22, s6, v22
  v_mul_f32 v23, s6, v23
  v_mul_f32 v24, s6, v24
  v_mul_f32 v25, s6, v25
  v_mul_f32 v26, s6, v26
  v_mul_f32 v27, s6, v27
  v_exp_f32 v20, v20
  v_exp_f32 v21, v21
  v_exp_f32 v22, v22
  v_exp_f32 v23, v23
  v_exp_f32 v24, v24
  v_exp_f32 v25, v25
  v_exp_f32 v26, v26
  v_exp_f32 v27, v27
  v_add_f32 v17, v17, v20
  v_cvt_pk_bf16_f32 v20, v20, v20
  v_add_f32 v17, v17, v21
  v_cvt_pk_bf16_f32 v21, v21, v21
  v_add_f32 v17, v17, v22
  v_cvt_pk_bf16_f32 v22, v22, v22
  v_add_f32 v17, v17, v23
  v_cvt_pk_bf16_f32 v23, v23, v23
  v_add_f32 v17, v17, v24
  v_cvt_pk_bf16_f32 v24, v24, v24
  v_add_f32 v17, v17, v25
  v_cvt_pk_bf16_f32 v25, v25, v25
  v_add_f32 v17, v17, v26
  v_cvt_pk_bf16_f32 v26, v26, v26
  v_add_f32 v17, v17, v27
  v_cvt_pk_bf16_f32 v27, v27, v27
  v_and_b32 v36, v20, v4
  v_and_b32 v37, v20, v5
  v_and_b32 v38, v20, v6
  v_and_b32 v39, v20, v7
  v_and_b32 v40, v21, v4
  v_and_b32 v41, v21, v5
  v_and_b32 v42, v21, v6
  v_and_b32 v43, v21, v7
  v_and_b32 v44, v22, v4
  v_and_b32 v45, v22, v5
  v_and_b32 v46, v22, v6
  v_and_b32 v47, v22, v7
  v_and_b32 v48, v23, v4
  v_and_b32 v49, v23, v5
  v_and_b32 v50, v23, v6
  v_and_b32 v51, v23, v7
  s_waitcnt vmcnt(4)
  s_nop 0
  v_mfma_f32_16x16x32_bf16 v[12:15], v[36:39], v[56:59], v[12:15]
  v_mfma_f32_16x16x32_bf16 v[12:15], v[40:43], v[60:63], v[12:15]
  v_mfma_f32_16x16x32_bf16 v[12:15], v[44:47], v[64:67], v[12:15]
  v_mfma_f32_16x16x32_bf16 v[12:15], v[48:51], v[68:71], v[12:15]
  buffer_load_dwordx4 v[56:59], v1, s[40:43], s52 offen offset:0 nt
  s_cmp_eq_u32 s61, 1
  s_cbranch_scc1 L_e5
  buffer_load_dwordx4 v[60:63], v1, s[40:43], s53 offen offset:0 nt
L_e5:
  v_and_b32 v36, v24, v4
  v_and_b32 v37, v24, v5
  v_and_b32 v38, v24, v6
  v_and_b32 v39, v24, v7
  v_and_b32 v40, v25, v4
  v_and_b32 v41, v25, v5
  v_and_b32 v42, v25, v6
  v_and_b32 v43, v25, v7
  v_and_b32 v44, v26, v4
  v_and_b32 v45, v26, v5
  v_and_b32 v46, v26, v6
  v_and_b32 v47, v26, v7
  v_and_b32 v48, v27, v4
  v_and_b32 v49, v27, v5
  v_and_b32 v50, v27, v6
  v_and_b32 v51, v27, v7
  s_cmp_eq_u32 s61, 1
  s_cbranch_scc1 L_l6s
  s_cmp_eq_u32 s61, 2
  s_cbranch_scc1 L_l6b
  s_waitcnt vmcnt(4)
  buffer_load_dwordx4 v[64:67], v1, s[40:43], s66 offen offset:0 nt
  s_waitcnt vmcnt(4)
  buffer_load_dwordx4 v[68:71], v1, s[40:43], s67 offen offset:0 nt
  s_branch L_l6x
L_l6s:
  s_waitcnt vmcnt(4)
  buffer_load_dwordx4 v[60:63], v1, s[40:43], s53 offen offset:0 nt
  s_waitcnt vmcnt(4)
  buffer_load_dwordx4 v[64:67], v1, s[40:43], s66 offen offset:0 nt
  s_waitcnt vmcnt(4)
  buffer_load_dwordx4 v[68:71], v1, s[40:43], s67 offen offset:0 nt
  s_branch L_l6x
L_l6b:
  s_waitcnt vmcnt(5)
  buffer_load_dwordx4 v[64:67], v1, s[40:43], s66 offen offset:0 nt
  buffer_load_dwordx4 v[68:71], v1, s[40:43], s67 offen offset:0 nt
L_l6x:
  s_waitcnt vmcnt(4)
  s_nop 0
  v_mfma_f32_16x16x32_bf16 v[12:15], v[36:39], v[72:75], v[12:15]
  v_mfma_f32_16x16x32_bf16 v[12:15], v[40:43], v[76:79], v[12:15]
  v_mfma_f32_16x16x32_bf16 v[12:15], v[44:47], v[80:83], v[12:15]
  v_mfma_f32_16x16x32_bf16 v[12:15], v[48:51], v[84:87], v[12:15]
  buffer_load_dwordx4 v[72:75], v1, s[40:43], s52 offen offset:2048 nt
  s_cmp_eq_u32 s61, 1
  s_cbranch_scc1 L_e7
  buffer_load_dwordx4 v[76:79], v1, s[40:43], s53 offen offset:2048 nt
L_e7:
  s_cmp_eq_u32 s61, 1
  s_cbranch_scc1 L_l8s
  s_cmp_eq_u32 s61, 2
  s_cbranch_scc1 L_l8b
  s_waitcnt vmcnt(4)
  buffer_load_dwordx4 v[80:83], v1, s[40:43], s66 offen offset:2048 nt
  s_waitcnt vmcnt(4)
  buffer_load_dwordx4 v[84:87], v1, s[40:43], s67 offen offset:2048 nt
  s_branch L_l8x
L_l8s:
  s_waitcnt vmcnt(4)
  buffer_load_dwordx4 v[76:79], v1, s[40:43], s53 offen offset:2048 nt
  s_waitcnt vmcnt(4)
  buffer_load_dwordx4 v[80:83], v1, s[40:43], s66 offen offset:2048 nt
  s_waitcnt vmcnt(4)
  buffer_load_dwordx4 v[84:87], v1, s[40:43], s67 offen offset:2048 nt
  s_branch L_l8x
L_l8b:
  s_waitcnt vmcnt(5)
  buffer_load_dwordx4 v[80:83], v1, s[40:43], s66 offen offset:2048 nt
  buffer_load_dwordx4 v[84:87], v1, s[40:43], s67 offen offset:2048 nt
L_l8x:
  s_branch L_loopV
L_ticket:
  s_cmp_eq_u32 s68, 0
  s_cbranch_scc1 L_ticket2
  s_mov_b32 s68, 0
L_waitpc:
  ds_read_b32 v19, v52 offset:292
  s_waitcnt lgkmcnt(0)
  v_cmp_gt_u32 vcc, 4, v19
  s_cbranch_vccnz L_waitpc
L_waitpf:
  ds_read_b32 v19, v52 offset:296
  s_waitcnt lgkmcnt(0)
  v_cmp_gt_u32 vcc, 1, v19
  s_cbranch_vccnz L_waitpf
  v_and_b32 v9, 7, v0
  v_lshlrev_b32 v9, 4, v9
  s_lshl_b32 s64, s3, 7
  v_add_u32 v9, s64, v9
  v_lshrrev_b32 v10, 2, v54
  v_add_u32 v10, v10, v9
  ds_read_b32 v8, v10 offset:2560
  ds_read_b32 v188, v52 offset:336
  v_lshrrev_b32 v10, 3, v0
  v_lshl_add_u32 v9, v10, 9, v9
  v_lshlrev_b32 v10, 4, v10
  v_lshlrev_b32 v55, 7, v54
  v_add_u32 v55, v55, v3
  s_add_u32 s65, s4, s5
  s_and_b32 s65, s65, 7
  s_lshl_b32 s44, s3, 16
  s_add_u32 s45, s44, 8192
  s_add_u32 s46, s44, 16384
  s_add_u32 s47, s44, 24576
  s_add_u32 s48, s44, 32768
  s_add_u32 s49, s44, 40960
  s_add_u32 s54, s44, 49152
  s_add_u32 s55, s44, 57344
  s_lshl_b32 s64, s65, 8
  v_add_u32 v34, s64, v55
  s_xor_b32 s63, s4, 0
  s_lshl_b32 s65, s63, 18
  s_add_u32 s24, s24, s65
  s_addc_u32 s25, s25, 0
  s_mov_b32 s26, 0x40000
  s_lshl_b32 s65, s4, 18
  v_add_u32 v34, s65, v34
  s_lshl_b32 s64, s5, 8
  v_add_u32 v55, s64, v55
  v_mov_b32 v3, v34
  s_lshl_b32 s56, s63, 12
  s_lshl_b32 s58, s5, 9
  s_add_u32 s58, s58, s56
  s_add_u32 s58, s58, 655360
  s_add_u32 s56, s56, 524288
  s_lshl_b32 s11, s63, 7
  s_add_u32 s11, s11, 65536
  s_lshl_b32 s57, s2, 9
  s_add_u32 s57, s57, 524288
  s_lshl_b32 s10, s2, 4
  s_add_u32 s10, s10, 65536
  s_waitcnt lgkmcnt(0)
  v_and_b32 v11, 1, v0
  v_lshlrev_b32 v11, 4, v11
  v_lshrrev_b32 v11, v11, v188
  v_bfe_u32 v184, v11, 0, 4
  v_bfe_u32 v185, v11, 4, 4
  v_bfe_u32 v186, v11, 8, 4
  v_bfe_u32 v187, v11, 12, 4
  s_mov_b32 s61, 2
L_ticket2:
  v_mov_b32 v35, 1
  s_mov_b64 exec, 1
  ds_add_rtn_u32 v35, v52, v35 offset:316
  s_mov_b64 exec, -1
  s_waitcnt lgkmcnt(0)
  v_readfirstlane_b32 s9, v35
  v_lshlrev_b32 v20, 16, v28
  v_and_b32 v21, s7, v28
  v_lshlrev_b32 v22, 16, v29
  v_and_b32 v23, s7, v29
  v_lshlrev_b32 v24, 16, v30
  v_and_b32 v25, s7, v30
  v_lshlrev_b32 v26, 16, v31
  v_and_b32 v27, s7, v31
  s_cmp_ge_u32 s9, 8
  s_cbranch_scc1 L_final
  s_mov_b32 s64, s9
  s_and_b32 s65, s9, 1
  s_lshl_b32 s65, s65, 12
  s_add_u32 s62, s69, s65
  s_bfe_u32 s65, s9, 0x10001
  s_lshl_b32 s65, s65, 15
  s_add_u32 s62, s62, s65
  s_lshr_b32 s70, s9, 2
  s_xor_b32 s64, s70, s73
  s_bfe_u32 s65, s64, 65536
  s_lshl_b32 s65, s65, 16
  s_add_u32 s52, s62, s65
  s_bfe_u32 s65, s64, 65537
  s_lshl_b32 s65, s65, 10
  s_add_u32 s52, s52, s65
  s_bfe_u32 s65, s64, 262146
  s_lshl_b32 s65, s65, 17
  s_add_u32 s52, s52, s65
  s_mov_b32 s64, s9
  s_add_u32 s53, s52, 8192
  s_add_u32 s66, s52, 16384
  s_add_u32 s67, s52, 24576
  s_lshl_b32 s64, s64, 6
  s_add_u32 s64, s64, 8192
  v_add_u32 v53, s64, v54
  v_max3_f32 v18, v20, v21, v22
  v_max3_f32 v19, v23, v24, v25
  v_max3_f32 v18, v18, v26, v27
  v_max_f32 v18, v18, v19
  v_cmp_gt_f32 vcc, v18, v16
  s_cbranch_vccz L_back_v
  s_branch L_resc_v
L_final:
  v_max3_f32 v18, v20, v21, v22
  v_max3_f32 v19, v23, v24, v25
  v_max3_f32 v18, v18, v26, v27
  v_max_f32 v18, v18, v19
  v_cmp_gt_f32 vcc, v18, v16
  s_cbranch_vccnz L_resc_f
L_back_f:
  v_sub_f32 v20, v20, v16
  v_sub_f32 v21, v21, v16
  v_sub_f32 v22, v22, v16
  v_sub_f32 v23, v23, v16
  v_sub_f32 v24, v24, v16
  v_sub_f32 v25, v25, v16
  v_sub_f32 v26, v26, v16
  v_sub_f32 v27, v27, v16
  v_mul_f32 v20, s6, v20
  v_mul_f32 v21, s6, v21
  v_mul_f32 v22, s6, v22
  v_mul_f32 v23, s6, v23
  v_mul_f32 v24, s6, v24
  v_mul_f32 v25, s6, v25
  v_mul_f32 v26, s6, v26
  v_mul_f32 v27, s6, v27
  v_exp_f32 v20, v20
  v_exp_f32 v21, v21
  v_exp_f32 v22, v22
  v_exp_f32 v23, v23
  v_exp_f32 v24, v24
  v_exp_f32 v25, v25
  v_exp_f32 v26, v26
  v_exp_f32 v27, v27
  v_add_f32 v17, v17, v20
  v_cvt_pk_bf16_f32 v20, v20, v20
  v_add_f32 v17, v17, v21
  v_cvt_pk_bf16_f32 v21, v21, v21
  v_add_f32 v17, v17, v22
  v_cvt_pk_bf16_f32 v22, v22, v22
  v_add_f32 v17, v17, v23
  v_cvt_pk_bf16_f32 v23, v23, v23
  v_add_f32 v17, v17, v24
  v_cvt_pk_bf16_f32 v24, v24, v24
  v_add_f32 v17, v17, v25
  v_cvt_pk_bf16_f32 v25, v25, v25
  v_add_f32 v17, v17, v26
  v_cvt_pk_bf16_f32 v26, v26, v26
  v_add_f32 v17, v17, v27
  v_cvt_pk_bf16_f32 v27, v27, v27
  v_and_b32 v36, v20, v4
  v_and_b32 v37, v20, v5
  v_and_b32 v38, v20, v6
  v_and_b32 v39, v20, v7
  v_and_b32 v40, v21, v4
  v_and_b32 v41, v21, v5
  v_and_b32 v42, v21, v6
  v_and_b32 v43, v21, v7
  v_and_b32 v44, v22, v4
  v_and_b32 v45, v22, v5
  v_and_b32 v46, v22, v6
  v_and_b32 v47, v22, v7
  v_and_b32 v48, v23, v4
  v_and_b32 v49, v23, v5
  v_and_b32 v50, v23, v6
  v_and_b32 v51, v23, v7
  s_waitcnt vmcnt(4)
  s_nop 0
  v_mfma_f32_16x16x32_bf16 v[12:15], v[36:39], v[56:59], v[12:15]
  v_mfma_f32_16x16x32_bf16 v[12:15], v[40:43], v[60:63], v[12:15]
  v_mfma_f32_16x16x32_bf16 v[12:15], v[44:47], v[64:67], v[12:15]
  v_mfma_f32_16x16x32_bf16 v[12:15], v[48:51], v[68:71], v[12:15]
  s_cmp_lt_u32 s9, 11
  s_cbranch_scc1 L_fin_nw
  buffer_load_dwordx4 v[120:123], v3, s[32:35], s44 offen nt
  buffer_load_dwordx4 v[124:127], v3, s[32:35], s45 offen nt
  v_and_b32 v36, v24, v4
  v_and_b32 v37, v24, v5
  v_and_b32 v38, v24, v6
  v_and_b32 v39, v24, v7
  v_and_b32 v40, v25, v4
  v_and_b32 v41, v25, v5
  v_and_b32 v42, v25, v6
  v_and_b32 v43, v25, v7
  v_and_b32 v44, v26, v4
  v_and_b32 v45, v26, v5
  v_and_b32 v46, v26, v6
  v_and_b32 v47, v26, v7
  v_and_b32 v48, v27, v4
  v_and_b32 v49, v27, v5
  v_and_b32 v50, v27, v6
  v_and_b32 v51, v27, v7
  s_waitcnt vmcnt(2)
  s_nop 0
  v_mfma_f32_16x16x32_bf16 v[12:15], v[36:39], v[72:75], v[12:15]
  v_mfma_f32_16x16x32_bf16 v[12:15], v[40:43], v[76:79], v[12:15]
  v_mfma_f32_16x16x32_bf16 v[12:15], v[44:47], v[80:83], v[12:15]
  v_mfma_f32_16x16x32_bf16 v[12:15], v[48:51], v[84:87], v[12:15]
  buffer_load_dwordx4 v[128:131], v3, s[32:35], s46 offen nt
  buffer_load_dwordx4 v[132:135], v3, s[32:35], s47 offen nt
  s_branch L_fin_j
L_fin_nw:
  v_and_b32 v36, v24, v4
  v_and_b32 v37, v24, v5
  v_and_b32 v38, v24, v6
  v_and_b32 v39, v24, v7
  v_and_b32 v40, v25, v4
  v_and_b32 v41, v25, v5
  v_and_b32 v42, v25, v6
  v_and_b32 v43, v25, v7
  v_and_b32 v44, v26, v4
  v_and_b32 v45, v26, v5
  v_and_b32 v46, v26, v6
  v_and_b32 v47, v26, v7
  v_and_b32 v48, v27, v4
  v_and_b32 v49, v27, v5
  v_and_b32 v50, v27, v6
  v_and_b32 v51, v27, v7
  s_waitcnt vmcnt(0)
  s_nop 0
  v_mfma_f32_16x16x32_bf16 v[12:15], v[36:39], v[72:75], v[12:15]
  v_mfma_f32_16x16x32_bf16 v[12:15], v[40:43], v[76:79], v[12:15]
  v_mfma_f32_16x16x32_bf16 v[12:15], v[44:47], v[80:83], v[12:15]
  v_mfma_f32_16x16x32_bf16 v[12:15], v[48:51], v[84:87], v[12:15]
L_fin_j:
  v_mov_b32 v19, v17
  s_lshl_b32 s64, s3, 9
  v_add_u32 v53, s64, v2
  v_permlane32_swap_b32 v17, v19
  s_lshl_b32 s64, s3, 3
  v_mov_b32 v20, s64
  v_add_f32 v17, v17, v19
  v_mov_b32 v19, v17
  v_mov_b32 v22, 1
  s_mov_b32 s74, 200000
  v_permlane16_swap_b32 v17, v19
  s_mov_b64 exec, 0xffffffff
  ds_write_b128 v53, v[12:15] offset:512
  v_add_f32 v17, v17, v19
  s_mov_b64 exec, 1
  ds_write_b64 v20, v[16:17] offset:256
  ds_add_rtn_u32 v23, v52, v22 offset:300
  s_mov_b64 exec, -1
  v_and_b32 v54, 0x1f0, v1
  s_waitcnt lgkmcnt(0)
  v_readfirstlane_b32 s64, v23
  s_nop 0
  s_cmp_lg_u32 s64, 3
  s_cbranch_scc1 L_notlast1
  ds_read_b128 v[28:31], v52 offset:256
  ds_read_b128 v[32:35], v52 offset:272
  ds_read_b128 v[36:39], v54 offset:512
  ds_read_b128 v[40:43], v54 offset:1024
  ds_read_b128 v[44:47], v54 offset:1536
  ds_read_b128 v[48:51], v54 offset:2048
  s_waitcnt lgkmcnt(4)
  v_max3_f32 v24, v28, v30, v32
  v_max_f32 v24, v24, v34
  v_sub_f32 v28, v28, v24
  v_sub_f32 v30, v30, v24
  v_sub_f32 v32, v32, v24
  v_sub_f32 v34, v34, v24
  v_mul_f32 v28, s6, v28
  v_mul_f32 v30, s6, v30
  v_mul_f32 v32, s6, v32
  v_mul_f32 v34, s6, v34
  v_exp_f32 v28, v28
  v_exp_f32 v30, v30
  v_exp_f32 v32, v32
  v_exp_f32 v34, v34
  s_waitcnt lgkmcnt(0)
  v_mul_f32 v25, v28, v29
  v_mul_f32 v56, v28, v36
  v_mul_f32 v57, v28, v37
  v_mul_f32 v58, v28, v38
  v_mul_f32 v59, v28, v39
  v_fmac_f32 v25, v30, v31
  v_fmac_f32 v56, v30, v40
  v_fmac_f32 v57, v30, v41
  v_fmac_f32 v58, v30, v42
  v_fmac_f32 v59, v30, v43
  v_fmac_f32 v25, v32, v33
  v_fmac_f32 v56, v32, v44
  v_fmac_f32 v57, v32, v45
  v_fmac_f32 v58, v32, v46
  v_fmac_f32 v59, v32, v47
  v_fmac_f32 v25, v34, v35
  v_fmac_f32 v56, v34, v48
  v_fmac_f32 v57, v34, v49
  v_fmac_f32 v58, v34, v50
  v_fmac_f32 v59, v34, v51
  v_add_u32 v26, s57, v1
  v_bfi_b32 v56, 15, v184, v56
  v_bfi_b32 v57, 15, v185, v57
  v_bfi_b32 v58, 15, v186, v58
  v_bfi_b32 v59, 15, v187, v59
  s_mov_b32 exec_lo, 0
  v_mov_b32 v56, v24
  v_mov_b32 v57, v188
  v_mov_b32 v58, v25
  v_mov_b32 v59, v188
  v_mov_b32 v26, s10
  s_mov_b32 exec_lo, -1
  s_mov_b32 exec_hi, 1
  buffer_store_dwordx4 v[56:59], v26, s[12:15], 0 offen sc1
  s_mov_b64 exec, 1
  ds_add_u32 v52, v22 offset:300
  s_mov_b64 exec, -1
L_notlast1:
  s_cmp_ge_u32 s9, 11
  s_cbranch_scc1 L_wrest
L_waitnl:
  ds_read_b32 v24, v52 offset:316
  s_waitcnt lgkmcnt(0)
  v_cmp_gt_u32 vcc, 12, v24
  s_cbranch_vccnz L_waitnl
  buffer_load_dwordx4 v[120:123], v3, s[32:35], s44 offen nt
  buffer_load_dwordx4 v[124:127], v3, s[32:35], s45 offen nt
  buffer_load_dwordx4 v[128:131], v3, s[32:35], s46 offen nt
  buffer_load_dwordx4 v[132:135], v3, s[32:35], s47 offen nt
L_wrest:
L_waitc:
  ds_read_b32 v24, v52 offset:300
  s_waitcnt lgkmcnt(0)
  v_cmp_gt_u32 vcc, 5, v24
  s_cbranch_vccnz L_waitc
  buffer_load_dwordx4 v[136:139], v3, s[32:35], s48 offen nt
  buffer_load_dwordx4 v[140:143], v3, s[32:35], s49 offen nt
  buffer_load_dwordx4 v[144:147], v3, s[32:35], s54 offen nt
  buffer_load_dwordx4 v[148:151], v3, s[32:35], s55 offen nt
  s_waitcnt vmcnt(6)
  buffer_load_dwordx4 v[88:91], v55, s[24:27], s44 offen nt
  buffer_load_dwordx4 v[92:95], v55, s[24:27], s45 offen nt
  buffer_load_dwordx4 v[96:99], v55, s[24:27], s46 offen nt
  buffer_load_dwordx4 v[100:103], v55, s[24:27], s47 offen nt
  buffer_load_dwordx4 v[104:107], v55, s[24:27], s48 offen nt
  buffer_load_dwordx4 v[108:111], v55, s[24:27], s49 offen nt
  buffer_load_dwordx4 v[112:115], v55, s[24:27], s54 offen nt
  buffer_load_dwordx4 v[116:119], v55, s[24:27], s55 offen nt
L_wall:
  s_waitcnt vmcnt(8)
L_wdok:
  v_and_b32_dpp v36, v8, v4 row_newbcast:0 row_mask:0xf bank_mask:0xf
  v_and_b32_dpp v37, v8, v5 row_newbcast:0 row_mask:0xf bank_mask:0xf
  v_and_b32_dpp v38, v8, v6 row_newbcast:0 row_mask:0xf bank_mask:0xf
  v_and_b32_dpp v39, v8, v7 row_newbcast:0 row_mask:0xf bank_mask:0xf
  v_and_b32_dpp v40, v8, v4 row_newbcast:1 row_mask:0xf bank_mask:0xf
  v_and_b32_dpp v41, v8, v5 row_newbcast:1 row_mask:0xf bank_mask:0xf
  v_and_b32_dpp v42, v8, v6 row_newbcast:1 row_mask:0xf bank_mask:0xf
  v_and_b32_dpp v43, v8, v7 row_newbcast:1 row_mask:0xf bank_mask:0xf
  v_mfma_f32_16x16x32_bf16 v[12:15], v[36:39], v[120:123], 0
  v_and_b32_dpp v44, v8, v4 row_newbcast:2 row_mask:0xf bank_mask:0xf
  v_and_b32_dpp v45, v8, v5 row_newbcast:2 row_mask:0xf bank_mask:0xf
  v_and_b32_dpp v46, v8, v6 row_newbcast:2 row_mask:0xf bank_mask:0xf
  v_and_b32_dpp v47, v8, v7 row_newbcast:2 row_mask:0xf bank_mask:0xf
  v_mfma_f32_16x16x32_bf16 v[12:15], v[40:43], v[124:127], v[12:15]
  v_and_b32_dpp v48, v8, v4 row_newbcast:3 row_mask:0xf bank_mask:0xf
  v_and_b32_dpp v49, v8, v5 row_newbcast:3 row_mask:0xf bank_mask:0xf
  v_and_b32_dpp v50, v8, v6 row_newbcast:3 row_mask:0xf bank_mask:0xf
  v_and_b32_dpp v51, v8, v7 row_newbcast:3 row_mask:0xf bank_mask:0xf
  v_mfma_f32_16x16x32_bf16 v[12:15], v[44:47], v[128:131], v[12:15]
  v_and_b32_dpp v36, v8, v4 row_newbcast:4 row_mask:0xf bank_mask:0xf
  v_and_b32_dpp v37, v8, v5 row_newbcast:4 row_mask:0xf bank_mask:0xf
  v_and_b32_dpp v38, v8, v6 row_newbcast:4 row_mask:0xf bank_mask:0xf
  v_and_b32_dpp v39, v8, v7 row_newbcast:4 row_mask:0xf bank_mask:0xf
  v_mfma_f32_16x16x32_bf16 v[12:15], v[48:51], v[132:135], v[12:15]
  v_and_b32_dpp v40, v8, v4 row_newbcast:5 row_mask:0xf bank_mask:0xf
  v_and_b32_dpp v41, v8, v5 row_newbcast:5 row_mask:0xf bank_mask:0xf
  v_and_b32_dpp v42, v8, v6 row_newbcast:5 row_mask:0xf bank_mask:0xf
  v_and_b32_dpp v43, v8, v7 row_newbcast:5 row_mask:0xf bank_mask:0xf
  v_mfma_f32_16x16x32_bf16 v[12:15], v[36:39], v[136:139], v[12:15]
  v_and_b32_dpp v44, v8, v4 row_newbcast:6 row_mask:0xf bank_mask:0xf
  v_and_b32_dpp v45, v8, v5 row_newbcast:6 row_mask:0xf bank_mask:0xf
  v_and_b32_dpp v46, v8, v6 row_newbcast:6 row_mask:0xf bank_mask:0xf
  v_and_b32_dpp v47, v8, v7 row_newbcast:6 row_mask:0xf bank_mask:0xf
  v_mfma_f32_16x16x32_bf16 v[12:15], v[40:43], v[140:143], v[12:15]
  v_and_b32_dpp v48, v8, v4 row_newbcast:7 row_mask:0xf bank_mask:0xf
  v_and_b32_dpp v49, v8, v5 row_newbcast:7 row_mask:0xf bank_mask:0xf
  v_and_b32_dpp v50, v8, v6 row_newbcast:7 row_mask:0xf bank_mask:0xf
  v_and_b32_dpp v51, v8, v7 row_newbcast:7 row_mask:0xf bank_mask:0xf
  v_mfma_f32_16x16x32_bf16 v[12:15], v[44:47], v[144:147], v[12:15]
  s_nop 1
  v_mfma_f32_16x16x32_bf16 v[12:15], v[48:51], v[148:151], v[12:15]
  s_nop 6
  s_mov_b64 exec, 0xffffffff
  ds_write_b128 v53, v[12:15] offset:4096
  s_mov_b64 exec, 1
  ds_add_u32 v52, v22 offset:304
  s_mov_b64 exec, -1
  s_waitcnt vmcnt(8)
  buffer_load_dwordx4 v[28:31], v9, s[12:15], s56 offen sc1
  buffer_load_dwordx4 v[32:35], v10, s[12:15], s11 offen sc1
  s_branch L_pollo_chk
L_pollo:
  s_sleep 1
  buffer_load_dwordx4 v[28:31], v9, s[12:15], s56 offen sc1
  buffer_load_dwordx4 v[32:35], v10, s[12:15], s11 offen sc1
L_pollo_chk:
  s_waitcnt vmcnt(0)
  v_xor_b32 v28, v184, v28
  v_xor_b32 v29, v185, v29
  v_xor_b32 v30, v186, v30
  v_xor_b32 v31, v187, v31
  v_xor_b32 v33, v188, v33
  v_xor_b32 v35, v188, v35
  v_or3_b32 v24, v28, v29, v30
  v_or_b32 v24, v24, v31
  v_and_b32 v24, 15, v24
  v_or3_b32 v24, v24, v33, v35
  v_cmp_ne_u32 vcc, 0, v24
  s_cbranch_vccz L_pollo_done
  s_sub_u32 s74, s74, 1
  s_cbranch_scc0 L_pollo
L_pollo_done:
  v_max_f32_dpp v24, v32, v32 row_ror:8 row_mask:0xf bank_mask:0xf
  v_mov_b32 v25, v24
  s_nop 1
  v_permlane16_swap_b32 v24, v25
  s_nop 0
  v_max_f32 v24, v24, v25
  v_mov_b32 v25, v24
  s_nop 1
  v_permlane32_swap_b32 v24, v25
  s_nop 0
  v_max_f32 v24, v24, v25
  v_sub_f32 v32, v32, v24
  v_mul_f32 v32, s6, v32
  v_exp_f32 v32, v32
  s_nop 0
  v_mul_f32 v33, v32, v34
  v_mul_f32 v28, v32, v28
  v_mul_f32 v29, v32, v29
  v_mul_f32 v30, v32, v30
  v_mul_f32 v31, v32, v31
  v_add_f32_dpp v33, v33, v33 row_ror:8 row_mask:0xf bank_mask:0xf
  s_nop 0
  v_permlane32_swap_b32 v28, v30
  v_permlane32_swap_b32 v29, v31
  v_mov_b32 v25, v33
  v_add_f32 v28, v28, v30
  v_add_f32 v29, v29, v31
  v_permlane16_swap_b32 v33, v25
  s_nop 0
  v_permlane16_swap_b32 v28, v29
  v_add_f32 v33, v33, v25
  v_mov_b32 v25, v33
  v_add_f32 v28, v28, v29
  s_nop 0
  v_permlane32_swap_b32 v33, v25
  v_add_f32_dpp v28, v28, v28 row_ror:8 row_mask:0xf bank_mask:0xf
  v_add_f32 v33, v33, v25
  v_rcp_f32 v33, v33
  s_nop 0
  v_mul_f32 v28, v28, v33
  v_cvt_pk_bf16_f32 v8, v28, v28
  s_waitcnt lgkmcnt(0)
  s_nop 0
  v_and_b32_dpp v36, v8, v4 row_newbcast:0 row_mask:0xf bank_mask:0xf
  v_and_b32_dpp v37, v8, v5 row_newbcast:0 row_mask:0xf bank_mask:0xf
  v_and_b32_dpp v38, v8, v6 row_newbcast:0 row_mask:0xf bank_mask:0xf
  v_and_b32_dpp v39, v8, v7 row_newbcast:0 row_mask:0xf bank_mask:0xf
  v_and_b32_dpp v40, v8, v4 row_newbcast:1 row_mask:0xf bank_mask:0xf
  v_and_b32_dpp v41, v8, v5 row_newbcast:1 row_mask:0xf bank_mask:0xf
  v_and_b32_dpp v42, v8, v6 row_newbcast:1 row_mask:0xf bank_mask:0xf
  v_and_b32_dpp v43, v8, v7 row_newbcast:1 row_mask:0xf bank_mask:0xf
  v_mfma_f32_16x16x32_bf16 v[12:15], v[36:39], v[88:91], 0
  v_and_b32_dpp v44, v8, v4 row_newbcast:2 row_mask:0xf bank_mask:0xf
  v_and_b32_dpp v45, v8, v5 row_newbcast:2 row_mask:0xf bank_mask:0xf
  v_and_b32_dpp v46, v8, v6 row_newbcast:2 row_mask:0xf bank_mask:0xf
  v_and_b32_dpp v47, v8, v7 row_newbcast:2 row_mask:0xf bank_mask:0xf
  v_mfma_f32_16x16x32_bf16 v[12:15], v[40:43], v[92:95], v[12:15]
  v_and_b32_dpp v48, v8, v4 row_newbcast:3 row_mask:0xf bank_mask:0xf
  v_and_b32_dpp v49, v8, v5 row_newbcast:3 row_mask:0xf bank_mask:0xf
  v_and_b32_dpp v50, v8, v6 row_newbcast:3 row_mask:0xf bank_mask:0xf
  v_and_b32_dpp v51, v8, v7 row_newbcast:3 row_mask:0xf bank_mask:0xf
  v_mfma_f32_16x16x32_bf16 v[12:15], v[44:47], v[96:99], v[12:15]
  v_and_b32_dpp v36, v8, v4 row_newbcast:4 row_mask:0xf bank_mask:0xf
  v_and_b32_dpp v37, v8, v5 row_newbcast:4 row_mask:0xf bank_mask:0xf
  v_and_b32_dpp v38, v8, v6 row_newbcast:4 row_mask:0xf bank_mask:0xf
  v_and_b32_dpp v39, v8, v7 row_newbcast:4 row_mask:0xf bank_mask:0xf
  v_mfma_f32_16x16x32_bf16 v[12:15], v[48:51], v[100:103], v[12:15]
  v_and_b32_dpp v40, v8, v4 row_newbcast:5 row_mask:0xf bank_mask:0xf
  v_and_b32_dpp v41, v8, v5 row_newbcast:5 row_mask:0xf bank_mask:0xf
  v_and_b32_dpp v42, v8, v6 row_newbcast:5 row_mask:0xf bank_mask:0xf
  v_and_b32_dpp v43, v8, v7 row_newbcast:5 row_mask:0xf bank_mask:0xf
  v_mfma_f32_16x16x32_bf16 v[12:15], v[36:39], v[104:107], v[12:15]
  v_and_b32_dpp v44, v8, v4 row_newbcast:6 row_mask:0xf bank_mask:0xf
  v_and_b32_dpp v45, v8, v5 row_newbcast:6 row_mask:0xf bank_mask:0xf
  v_and_b32_dpp v46, v8, v6 row_newbcast:6 row_mask:0xf bank_mask:0xf
  v_and_b32_dpp v47, v8, v7 row_newbcast:6 row_mask:0xf bank_mask:0xf
  v_mfma_f32_16x16x32_bf16 v[12:15], v[40:43], v[108:111], v[12:15]
  v_and_b32_dpp v48, v8, v4 row_newbcast:7 row_mask:0xf bank_mask:0xf
  v_and_b32_dpp v49, v8, v5 row_newbcast:7 row_mask:0xf bank_mask:0xf
  v_and_b32_dpp v50, v8, v6 row_newbcast:7 row_mask:0xf bank_mask:0xf
  v_and_b32_dpp v51, v8, v7 row_newbcast:7 row_mask:0xf bank_mask:0xf
  v_mfma_f32_16x16x32_bf16 v[12:15], v[44:47], v[112:115], v[12:15]
  s_nop 1
  v_mfma_f32_16x16x32_bf16 v[12:15], v[48:51], v[116:119], v[12:15]
  s_nop 6
  s_mov_b64 exec, 0xffffffff
  ds_write_b128 v53, v[12:15] offset:6144
  s_mov_b64 exec, 1
  ds_add_rtn_u32 v23, v52, v22 offset:308
  s_mov_b64 exec, -1
  s_waitcnt lgkmcnt(0)
  v_readfirstlane_b32 s64, v23
  s_nop 0
  s_cmp_lg_u32 s64, 3
  s_cbranch_scc1 L_notlast3
  ds_read_b128 v[36:39], v54 offset:6144
  ds_read_b128 v[40:43], v54 offset:6656
  ds_read_b128 v[44:47], v54 offset:7168
  ds_read_b128 v[48:51], v54 offset:7680
  s_waitcnt lgkmcnt(0)
  v_add_f32 v36, v36, v40
  v_add_f32 v37, v37, v41
  v_add_f32 v38, v38, v42
  v_add_f32 v39, v39, v43
  v_add_f32 v44, v44, v48
  v_add_f32 v45, v45, v49
  v_add_f32 v46, v46, v50
  v_add_f32 v47, v47, v51
  v_add_f32 v60, v36, v44
  v_add_f32 v61, v37, v45
  v_add_f32 v62, v38, v46
  v_add_f32 v63, v39, v47
  v_bfi_b32 v60, 15, v184, v60
  v_bfi_b32 v61, 15, v185, v61
  v_bfi_b32 v62, 15, v186, v62
  v_bfi_b32 v63, 15, v187, v63
  s_mov_b64 exec, 0xffffffff
  buffer_store_dwordx4 v[60:63], v1, s[12:15], s58 offen sc1
L_notlast3:
  s_endpgm
L_resc_v:
  v_max_f32 v18, v18, v16
  v_mov_b32 v19, v18
  s_nop 1
  v_permlane32_swap_b32 v18, v19
  s_nop 0
  v_max_f32 v18, v18, v19
  v_mov_b32 v19, v18
  s_nop 1
  v_permlane16_swap_b32 v18, v19
  s_nop 0
  v_max_f32 v18, v18, v19
  v_sub_f32 v19, v16, v18
  v_mul_f32 v19, s6, v19
  v_exp_f32 v19, v19
  v_mov_b32 v16, v18
  v_mul_f32 v17, v17, v19
  v_mul_f32 v12, v12, v19
  v_mul_f32 v13, v13, v19
  v_mul_f32 v14, v14, v19
  v_mul_f32 v15, v15, v19
  s_branch L_back_v
L_resc_f:
  v_max_f32 v18, v18, v16
  v_mov_b32 v19, v18
  s_nop 1
  v_permlane32_swap_b32 v18, v19
  s_nop 0
  v_max_f32 v18, v18, v19
  v_mov_b32 v19, v18
  s_nop 1
  v_permlane16_swap_b32 v18, v19
  s_nop 0
  v_max_f32 v18, v18, v19
  v_sub_f32 v19, v16, v18
  v_mul_f32 v19, s6, v19
  v_exp_f32 v19, v19
  v_mov_b32 v16, v18
  v_mul_f32 v17, v17, v19
  v_mul_f32 v12, v12, v19
  v_mul_f32 v13, v13, v19
  v_mul_f32 v14, v14, v19
  v_mul_f32 v15, v15, v19
  s_branch L_back_f
L_svc2:
  v_mov_b32 v40, 0
  v_mov_b32 v41, 0
  v_mov_b32 v42, 0
  v_mov_b32 v43, 0
  s_lshl_b32 s9, s4, 2
  s_add_u32 s9, s9, s5
  s_lshl_b32 s9, s9, 8
  s_add_u32 s9, s9, 31744
  s_cmp_ge_u32 s5, 4
  s_cselect_b32 s9, s9, 0x7f000000
  s_mov_b64 exec, 3
  buffer_store_dwordx4 v[40:43], v1, s[12:15], s9 offen sc1
  s_mov_b64 exec, -1
  s_mov_b32 s55, 50176
  s_mov_b32 s9, 229376
  v_mul_lo_u32 v24, v26, s9
  v_add_u32 v24, v24, v27
  s_movk_i32 s45, 7168
  s_bitcmp1_b32 s5, 0
  s_cselect_b64 s[40:41], s[30:31], s[28:29]
  s_cmp_lt_u32 s4, 28
  s_cselect_b32 s42, 7340032, 0
  s_xor_b32 s44, s5, 0
  s_mul_i32 s44, s44, 917504
  s_lshl_b32 s9, s4, 8
  s_add_u32 s44, s44, s9
  s_call_b64 s[46:47], L_loadtile
  s_waitcnt vmcnt(0)
  s_call_b64 s[46:47], L_matvec
  v_mov_b32 v60, v12
  v_mov_b32 v61, v13
  v_mov_b32 v62, v14
  v_mov_b32 v63, v15
  s_xor_b32 s44, s5, 1
  s_mul_i32 s44, s44, 917504
  s_lshl_b32 s9, s4, 8
  s_add_u32 s44, s44, s9
  s_call_b64 s[46:47], L_loadtile
  v_mov_b32 v8, v58
  v_mov_b32 v9, v59
  s_waitcnt vmcnt(0)
  s_call_b64 s[46:47], L_matvec
  v_add_f32 v60, v60, v12
  v_add_f32 v61, v61, v13
  v_add_f32 v62, v62, v14
  v_add_f32 v63, v63, v15
  v_bfi_b32 v60, 15, v64, v60
  v_bfi_b32 v61, 15, v65, v61
  v_bfi_b32 v62, 15, v66, v62
  v_bfi_b32 v63, 15, v67, v63
  s_mov_b64 exec, 0xffffffff
  buffer_store_dwordx4 v[60:63], v1, s[12:15], s60 offen sc1
  s_mov_b64 exec, -1
  s_mov_b32 s74, 200000
L_pollgu:
  s_sleep 32
  buffer_load_dwordx4 v[32:35], v1, s[12:15], s67 offen offset:0 sc1
  buffer_load_dwordx4 v[36:39], v1, s[12:15], s67 offen offset:1024 sc1
  buffer_load_dwordx4 v[40:43], v1, s[12:15], s67 offen offset:2048 sc1
  buffer_load_dwordx4 v[44:47], v1, s[12:15], s67 offen offset:3072 sc1
  s_waitcnt vmcnt(0)
  v_xor_b32 v32, v64, v32
  v_xor_b32 v33, v65, v33
  v_xor_b32 v34, v66, v34
  v_xor_b32 v35, v67, v35
  v_xor_b32 v36, v64, v36
  v_xor_b32 v37, v65, v37
  v_xor_b32 v38, v66, v38
  v_xor_b32 v39, v67, v39
  v_xor_b32 v40, v64, v40
  v_xor_b32 v41, v65, v41
  v_xor_b32 v42, v66, v42
  v_xor_b32 v43, v67, v43
  v_xor_b32 v44, v64, v44
  v_xor_b32 v45, v65, v45
  v_xor_b32 v46, v66, v46
  v_xor_b32 v47, v67, v47
  v_or3_b32 v28, v32, v33, v34
  v_or3_b32 v29, v35, v36, v37
  v_or3_b32 v28, v28, v38, v39
  v_or3_b32 v29, v29, v40, v41
  v_or3_b32 v28, v28, v42, v43
  v_or3_b32 v29, v29, v44, v45
  v_or3_b32 v28, v28, v46, v47
  v_or_b32 v28, v28, v29
  v_and_b32 v28, 15, v28
  v_cmp_ne_u32 vcc, 0, v28
  s_cbranch_vccz L_pollgu_done
  s_sub_u32 s74, s74, 1
  s_cbranch_scc0 L_pollgu
L_pollgu_done:
  v_add_f32 v32, v32, v40
  v_add_f32 v33, v33, v41
  v_add_f32 v34, v34, v42
  v_add_f32 v35, v35, v43
  v_add_f32 v36, v36, v44
  v_add_f32 v37, v37, v45
  v_add_f32 v38, v38, v46
  v_add_f32 v39, v39, v47
  v_add_f32 v32, v32, v36
  v_add_f32 v33, v33, v37
  v_add_f32 v34, v34, v38
  v_add_f32 v35, v35, v39
  v_cvt_pk_bf16_f32 v32, v32, v33
  v_cvt_pk_bf16_f32 v33, v34, v35
  v_mov_b32 v34, v32
  v_mov_b32 v35, v33
  s_nop 1
  v_permlane32_swap_b32 v32, v34
  v_permlane32_swap_b32 v33, v35
  s_nop 0
  v_lshlrev_b32 v36, 16, v32
  v_and_b32 v37, s7, v32
  v_lshlrev_b32 v48, 16, v34
  v_and_b32 v49, s7, v34
  v_lshlrev_b32 v38, 16, v33
  v_and_b32 v39, s7, v33
  v_lshlrev_b32 v50, 16, v35
  v_and_b32 v51, s7, v35
  v_mul_f32 v36, s6, v36
  v_mul_f32 v37, s6, v37
  v_mul_f32 v38, s6, v38
  v_mul_f32 v39, s6, v39
  v_exp_f32 v36, -v36
  v_exp_f32 v37, -v37
  v_exp_f32 v38, -v38
  v_exp_f32 v39, -v39
  v_add_f32 v36, 1.0, v36
  v_add_f32 v37, 1.0, v37
  v_add_f32 v38, 1.0, v38
  v_add_f32 v39, 1.0, v39
  v_rcp_f32 v36, v36
  v_rcp_f32 v37, v37
  v_rcp_f32 v38, v38
  v_rcp_f32 v39, v39
  s_nop 0
  v_cvt_pk_bf16_f32 v32, v36, v37
  v_cvt_pk_bf16_f32 v33, v38, v39
  v_lshlrev_b32 v36, 16, v32
  v_and_b32 v37, s7, v32
  v_lshlrev_b32 v38, 16, v33
  v_and_b32 v39, s7, v33
  v_mul_f32 v36, v36, v48
  v_mul_f32 v37, v37, v49
  v_mul_f32 v38, v38, v50
  v_mul_f32 v39, v39, v51
  v_cvt_pk_bf16_f32 v44, v36, v36
  v_cvt_pk_bf16_f32 v45, v37, v37
  v_cvt_pk_bf16_f32 v46, v38, v38
  v_cvt_pk_bf16_f32 v47, v39, v39
  s_mov_b64 exec, 0xffffffff
  ds_write_b128 v2, v[44:47] offset:2560
  s_mov_b64 exec, -1
  ds_write_b32 v30, v56 offset:336
  s_waitcnt lgkmcnt(0)
  ds_write_b32 v30, v31 offset:296
  s_add_u32 s63, s4, s5
  s_and_b32 s63, s63, 7
  s_lshl_b32 s63, s63, 5
  s_add_u32 s63, s63, s4
  s_lshl_b32 s63, s63, 9
  s_add_u32 s63, s63, 393216
  v_and_b32 v3, 0x1f0, v1
  s_mov_b32 s60, 96
  s_mov_b32 s62, 0
L_ctl:
  s_sleep 4
  ds_read_b128 v[32:35], v30 offset:320
  s_waitcnt lgkmcnt(0)
  v_add3_u32 v32, v32, v33, v34
  v_add_u32 v32, v32, v35
  v_cmp_gt_u32 vcc, s60, v32
  s_cbranch_vccnz L_ctl
  v_mov_b32 v32, 1
  s_mov_b64 exec, 1
  s_lshl_b32 s65, s62, 1
  s_add_u32 s65, s65, 1
  s_mul_i32 s65, s65, s5
  s_add_u32 s65, s65, s4
  s_and_b32 s65, s65, 31
  s_lshl_b32 s65, s65, 2
  s_and_b32 s9, s62, 3
  s_add_u32 s65, s65, s9
  s_lshl_b32 s65, s65, 8
  s_andn2_b32 s9, s62, 3
  s_add_u32 s65, s65, s9
  s_add_u32 s65, s65, 32768
  buffer_atomic_add v32, off, s[12:15], s65 sc0 sc1
  s_waitcnt vmcnt(0)
  v_readfirstlane_b32 s9, v32
  s_mov_b32 s64, 0
  s_cmp_lt_u32 s9, 3
  s_cselect_b32 s64, 1, s64
  s_cmp_ge_u32 s9, 6
  s_cselect_b32 s64, 2, s64
  v_mov_b32 v32, s64
  ds_write_b32 v30, v32 offset:312
  s_mov_b64 exec, -1
  s_add_u32 s60, s60, 24
  s_add_u32 s62, s62, 1
  s_cmp_lt_u32 s62, 17
  s_cbranch_scc1 L_ctl
  s_setprio 3
  s_cmp_lt_u32 s4, 28
  s_cbranch_scc1 L_waitb
  s_mov_b32 s56, s34
  s_mov_b32 s57, s35
  s_movk_i32 s58, 2048
  s_mov_b32 s59, 0x20000
  v_lshrrev_b32 v28, 3, v0
  v_and_b32 v29, 0x70, v1
  v_lshl_add_u32 v24, v28, 9, v29
  v_lshl_add_u32 v27, v28, 12, v29
  v_and_b32 v28, 7, v0
  v_lshlrev_b32 v28, 3, v28
  v_lshl_add_u32 v25, v26, 1, v28
  s_and_b32 s9, s4, 3
  s_lshl_b32 s68, s9, 6
  s_add_u32 s68, s68, s8
  s_lshl_b32 s69, s5, 14
  s_lshl_b32 s9, s9, 7
  s_add_u32 s69, s69, s9
  s_lshl_b32 s61, s5, 9
  s_add_u32 s61, s61, s9
  s_add_u32 s61, s61, 655360
  buffer_load_ushort v58, v25, s[48:51], s68 offen
L_waitc1:
  s_sleep 2
  ds_read_b32 v29, v30 offset:300
  s_waitcnt lgkmcnt(0)
  v_cmp_gt_u32 vcc, 1, v29
  s_cbranch_vccnz L_waitc1
  s_add_u32 s70, s69, 393216
  buffer_load_dwordx4 v[88:91], v24, s[12:15], s70 offen sc1
  s_add_u32 s70, s61, 0
  buffer_load_dwordx4 v[104:107], v27, s[12:15], s70 offen sc1
  s_add_u32 s70, s69, 397312
  buffer_load_dwordx4 v[92:95], v24, s[12:15], s70 offen sc1
  s_add_u32 s70, s61, 32768
  buffer_load_dwordx4 v[108:111], v27, s[12:15], s70 offen sc1
  s_add_u32 s70, s69, 401408
  buffer_load_dwordx4 v[96:99], v24, s[12:15], s70 offen sc1
  s_add_u32 s70, s61, 65536
  buffer_load_dwordx4 v[112:115], v27, s[12:15], s70 offen sc1
  s_add_u32 s70, s69, 405504
  buffer_load_dwordx4 v[100:103], v24, s[12:15], s70 offen sc1
  s_add_u32 s70, s61, 98304
  buffer_load_dwordx4 v[116:119], v27, s[12:15], s70 offen sc1
L_waitb:
  s_sleep 1
  ds_read_b32 v29, v30 offset:304
  s_waitcnt lgkmcnt(0)
  v_cmp_gt_u32 vcc, 4, v29
  s_cbranch_vccnz L_waitb
  ds_read_b128 v[36:39], v3 offset:4096
  ds_read_b128 v[40:43], v3 offset:4608
  ds_read_b128 v[44:47], v3 offset:5120
  ds_read_b128 v[48:51], v3 offset:5632
  s_waitcnt lgkmcnt(0)
  v_add_f32 v36, v36, v40
  v_add_f32 v37, v37, v41
  v_add_f32 v38, v38, v42
  v_add_f32 v39, v39, v43
  v_add_f32 v44, v44, v48
  v_add_f32 v45, v45, v49
  v_add_f32 v46, v46, v50
  v_add_f32 v47, v47, v51
  v_add_f32 v60, v36, v44
  v_add_f32 v61, v37, v45
  v_add_f32 v62, v38, v46
  v_add_f32 v63, v39, v47
  v_bfi_b32 v60, 15, v64, v60
  v_bfi_b32 v61, 15, v65, v61
  v_bfi_b32 v62, 15, v66, v62
  v_bfi_b32 v63, 15, v67, v63
  s_mov_b64 exec, 0xffffffff
  buffer_store_dwordx4 v[60:63], v1, s[12:15], s63 offen sc1
  s_mov_b64 exec, -1
  s_cmp_lt_u32 s4, 28
  s_cbranch_scc1 L_svc_end
  s_add_u32 s70, s69, 393216
  s_add_u32 s71, s69, 397312
  s_add_u32 s72, s69, 401408
  s_add_u32 s73, s69, 405504
  s_mov_b32 s74, 200000
  buffer_load_dwordx4 v[120:123], v24, s[12:15], s70 offen sc1
  buffer_load_dwordx4 v[124:127], v24, s[12:15], s71 offen sc1
  buffer_load_dwordx4 v[128:131], v24, s[12:15], s72 offen sc1
  buffer_load_dwordx4 v[132:135], v24, s[12:15], s73 offen sc1
  s_sleep 4
L_fgb:
  buffer_load_dwordx4 v[136:139], v24, s[12:15], s70 offen sc1
  buffer_load_dwordx4 v[140:143], v24, s[12:15], s71 offen sc1
  buffer_load_dwordx4 v[144:147], v24, s[12:15], s72 offen sc1
  buffer_load_dwordx4 v[148:151], v24, s[12:15], s73 offen sc1
  s_waitcnt vmcnt(4)
  v_xor_b32 v120, v64, v120
  v_xor_b32 v121, v65, v121
  v_xor_b32 v122, v66, v122
  v_xor_b32 v123, v67, v123
  v_xor_b32 v124, v64, v124
  v_xor_b32 v125, v65, v125
  v_xor_b32 v126, v66, v126
  v_xor_b32 v127, v67, v127
  v_xor_b32 v128, v64, v128
  v_xor_b32 v129, v65, v129
  v_xor_b32 v130, v66, v130
  v_xor_b32 v131, v67, v131
  v_xor_b32 v132, v64, v132
  v_xor_b32 v133, v65, v133
  v_xor_b32 v134, v66, v134
  v_xor_b32 v135, v67, v135
  v_or3_b32 v28, v120, v121, v122
  v_or3_b32 v29, v123, v124, v125
  v_or3_b32 v28, v28, v126, v127
  v_or3_b32 v29, v29, v128, v129
  v_or3_b32 v28, v28, v130, v131
  v_or3_b32 v29, v29, v132, v133
  v_or3_b32 v28, v28, v134, v135
  v_or_b32 v28, v28, v29
  v_and_b32 v28, 15, v28
  v_cmp_ne_u32 vcc, 0, v28
  s_cbranch_vccz L_fgb_d0
  buffer_load_dwordx4 v[120:123], v24, s[12:15], s70 offen sc1
  buffer_load_dwordx4 v[124:127], v24, s[12:15], s71 offen sc1
  buffer_load_dwordx4 v[128:131], v24, s[12:15], s72 offen sc1
  buffer_load_dwordx4 v[132:135], v24, s[12:15], s73 offen sc1
  s_waitcnt vmcnt(4)
  v_xor_b32 v136, v64, v136
  v_xor_b32 v137, v65, v137
  v_xor_b32 v138, v66, v138
  v_xor_b32 v139, v67, v139
  v_xor_b32 v140, v64, v140
  v_xor_b32 v141, v65, v141
  v_xor_b32 v142, v66, v142
  v_xor_b32 v143, v67, v143
  v_xor_b32 v144, v64, v144
  v_xor_b32 v145, v65, v145
  v_xor_b32 v146, v66, v146
  v_xor_b32 v147, v67, v147
  v_xor_b32 v148, v64, v148
  v_xor_b32 v149, v65, v149
  v_xor_b32 v150, v66, v150
  v_xor_b32 v151, v67, v151
  v_or3_b32 v28, v136, v137, v138
  v_or3_b32 v29, v139, v140, v141
  v_or3_b32 v28, v28, v142, v143
  v_or3_b32 v29, v29, v144, v145
  v_or3_b32 v28, v28, v146, v147
  v_or3_b32 v29, v29, v148, v149
  v_or3_b32 v28, v28, v150, v151
  v_or_b32 v28, v28, v29
  v_and_b32 v28, 15, v28
  v_cmp_ne_u32 vcc, 0, v28
  s_cbranch_vccz L_fgb_d1
  s_sub_u32 s74, s74, 1
  s_cbranch_scc0 L_fgb
L_fgb_d1:
  v_add_f32 v136, v136, v140
  v_add_f32 v137, v137, v141
  v_add_f32 v138, v138, v142
  v_add_f32 v139, v139, v143
  v_add_f32 v144, v144, v148
  v_add_f32 v145, v145, v149
  v_add_f32 v146, v146, v150
  v_add_f32 v147, v147, v151
  v_add_f32 v48, v136, v144
  v_add_f32 v49, v137, v145
  v_add_f32 v50, v138, v146
  v_add_f32 v51, v139, v147
  s_branch L_fgb_f
L_fgb_d0:
  v_add_f32 v120, v120, v124
  v_add_f32 v121, v121, v125
  v_add_f32 v122, v122, v126
  v_add_f32 v123, v123, v127
  v_add_f32 v128, v128, v132
  v_add_f32 v129, v129, v133
  v_add_f32 v130, v130, v134
  v_add_f32 v131, v131, v135
  v_add_f32 v48, v120, v128
  v_add_f32 v49, v121, v129
  v_add_f32 v50, v122, v130
  v_add_f32 v51, v123, v131
L_fgb_f:
  s_nop 1
  v_permlane32_swap_b32 v48, v50
  v_permlane32_swap_b32 v49, v51
  s_nop 0
  v_add_f32 v48, v48, v50
  v_add_f32 v49, v49, v51
  s_nop 1
  v_permlane16_swap_b32 v48, v49
  s_nop 0
  v_add_f32 v48, v48, v49
  s_nop 1
  v_add_f32_dpp v48, v48, v48 row_ror:8 row_mask:0xf bank_mask:0xf
  v_cvt_pk_bf16_f32 v59, v48, v48
  v_and_b32 v59, s7, v59
  v_lshlrev_b32 v58, 16, v58
  s_add_u32 s70, s61, 0
  s_add_u32 s71, s61, 32768
  s_add_u32 s72, s61, 65536
  s_add_u32 s73, s61, 98304
  s_mov_b32 s74, 200000
  buffer_load_dwordx4 v[152:155], v27, s[12:15], s70 offen sc1
  buffer_load_dwordx4 v[156:159], v27, s[12:15], s71 offen sc1
  buffer_load_dwordx4 v[160:163], v27, s[12:15], s72 offen sc1
  buffer_load_dwordx4 v[164:167], v27, s[12:15], s73 offen sc1
  s_sleep 4
L_fga:
  buffer_load_dwordx4 v[168:171], v27, s[12:15], s70 offen sc1
  buffer_load_dwordx4 v[172:175], v27, s[12:15], s71 offen sc1
  buffer_load_dwordx4 v[176:179], v27, s[12:15], s72 offen sc1
  buffer_load_dwordx4 v[180:183], v27, s[12:15], s73 offen sc1
  s_waitcnt vmcnt(4)
  v_xor_b32 v152, v64, v152
  v_xor_b32 v153, v65, v153
  v_xor_b32 v154, v66, v154
  v_xor_b32 v155, v67, v155
  v_xor_b32 v156, v64, v156
  v_xor_b32 v157, v65, v157
  v_xor_b32 v158, v66, v158
  v_xor_b32 v159, v67, v159
  v_xor_b32 v160, v64, v160
  v_xor_b32 v161, v65, v161
  v_xor_b32 v162, v66, v162
  v_xor_b32 v163, v67, v163
  v_xor_b32 v164, v64, v164
  v_xor_b32 v165, v65, v165
  v_xor_b32 v166, v66, v166
  v_xor_b32 v167, v67, v167
  v_or3_b32 v28, v152, v153, v154
  v_or3_b32 v29, v155, v156, v157
  v_or3_b32 v28, v28, v158, v159
  v_or3_b32 v29, v29, v160, v161
  v_or3_b32 v28, v28, v162, v163
  v_or3_b32 v29, v29, v164, v165
  v_or3_b32 v28, v28, v166, v167
  v_or_b32 v28, v28, v29
  v_and_b32 v28, 15, v28
  v_cmp_ne_u32 vcc, 0, v28
  s_cbranch_vccz L_fga_d0
  buffer_load_dwordx4 v[152:155], v27, s[12:15], s70 offen sc1
  buffer_load_dwordx4 v[156:159], v27, s[12:15], s71 offen sc1
  buffer_load_dwordx4 v[160:163], v27, s[12:15], s72 offen sc1
  buffer_load_dwordx4 v[164:167], v27, s[12:15], s73 offen sc1
  s_waitcnt vmcnt(4)
  v_xor_b32 v168, v64, v168
  v_xor_b32 v169, v65, v169
  v_xor_b32 v170, v66, v170
  v_xor_b32 v171, v67, v171
  v_xor_b32 v172, v64, v172
  v_xor_b32 v173, v65, v173
  v_xor_b32 v174, v66, v174
  v_xor_b32 v175, v67, v175
  v_xor_b32 v176, v64, v176
  v_xor_b32 v177, v65, v177
  v_xor_b32 v178, v66, v178
  v_xor_b32 v179, v67, v179
  v_xor_b32 v180, v64, v180
  v_xor_b32 v181, v65, v181
  v_xor_b32 v182, v66, v182
  v_xor_b32 v183, v67, v183
  v_or3_b32 v28, v168, v169, v170
  v_or3_b32 v29, v171, v172, v173
  v_or3_b32 v28, v28, v174, v175
  v_or3_b32 v29, v29, v176, v177
  v_or3_b32 v28, v28, v178, v179
  v_or3_b32 v29, v29, v180, v181
  v_or3_b32 v28, v28, v182, v183
  v_or_b32 v28, v28, v29
  v_and_b32 v28, 15, v28
  v_cmp_ne_u32 vcc, 0, v28
  s_cbranch_vccz L_fga_d1
  s_sub_u32 s74, s74, 1
  s_cbranch_scc0 L_fga
L_fga_d1:
  v_add_f32 v168, v168, v172
  v_add_f32 v169, v169, v173
  v_add_f32 v170, v170, v174
  v_add_f32 v171, v171, v175
  v_add_f32 v176, v176, v180
  v_add_f32 v177, v177, v181
  v_add_f32 v178, v178, v182
  v_add_f32 v179, v179, v183
  v_add_f32 v48, v168, v176
  v_add_f32 v49, v169, v177
  v_add_f32 v50, v170, v178
  v_add_f32 v51, v171, v179
  s_branch L_fga_f
L_fga_d0:
  v_add_f32 v152, v152, v156
  v_add_f32 v153, v153, v157
  v_add_f32 v154, v154, v158
  v_add_f32 v155, v155, v159
  v_add_f32 v160, v160, v164
  v_add_f32 v161, v161, v165
  v_add_f32 v162, v162, v166
  v_add_f32 v163, v163, v167
  v_add_f32 v48, v152, v160
  v_add_f32 v49, v153, v161
  v_add_f32 v50, v154, v162
  v_add_f32 v51, v155, v163
L_fga_f:
  s_nop 1
  v_permlane32_swap_b32 v48, v50
  v_permlane32_swap_b32 v49, v51
  s_nop 0
  v_add_f32 v48, v48, v50
  v_add_f32 v49, v49, v51
  s_nop 1
  v_permlane16_swap_b32 v48, v49
  s_nop 0
  v_add_f32 v48, v48, v49
  s_nop 1
  v_add_f32_dpp v48, v48, v48 row_ror:8 row_mask:0xf bank_mask:0xf
  v_cvt_pk_bf16_f32 v48, v48, v48
  v_and_b32 v48, s7, v48
  v_add_f32 v48, v58, v48
  v_cvt_pk_bf16_f32 v48, v48, v48
  v_and_b32 v48, s7, v48
  v_add_f32 v48, v48, v59
  v_cvt_pk_bf16_f32 v48, v48, v48
  s_mov_b32 exec_lo, 0x00ff00ff
  s_mov_b32 exec_hi, 0x00ff00ff
  buffer_store_short v48, v25, s[56:59], s68 offen
  s_cmp_lg_u32 s2, 255
  s_cbranch_scc1 L_svc_end
  s_mov_b64 exec, 1
  buffer_store_dword v56, off, s[12:15], 0 offset:0 sc1
L_svc_end:
L_end:
  s_endpgm
L_codeend:
.section .rodata,"a"
.p2align 6
.amdhsa_kernel parallel_sum__mha_block_cached__glu_gated_glu__decode_kernel
  .amdhsa_next_free_vgpr 216
  .amdhsa_next_free_sgpr 96
  .amdhsa_accum_offset 216
  .amdhsa_group_segment_fixed_size 0
  .amdhsa_kernarg_size 96
  .amdhsa_user_sgpr_count 2
  .amdhsa_user_sgpr_kernarg_segment_ptr 1
  .amdhsa_system_sgpr_workgroup_id_x 1
  .amdhsa_float_denorm_mode_32 3
.end_amdhsa_kernel
```
